```python
import torch

def _softmax(x, axis=-1):
    return torch.softmax(x, dim=axis)
def _gelu(x):
    return torch.nn.functional.gelu(x, approximate="tanh")
def _silu(x):
    return torch.nn.functional.silu(x)
def _sigmoid(x):
    return torch.sigmoid(x)
def _layernorm(x, axis=-1, eps=1e-5):
    m = x.mean(dim=axis, keepdim=True)
    v = x.var(dim=axis, keepdim=True, unbiased=False)
    return (x - m) / torch.sqrt(v + eps)
def _scatter_add(tgt, idx, src, axis=0):
    return tgt.clone().index_add_(axis, idx, src)
def _segment_sum(src, seg, n):
    out = torch.zeros((n,) + src.shape[1:], dtype=src.dtype)
    return out.index_add_(0, seg, src)
def _pad(x, pw):
    flat = tuple(v for pair in reversed(pw) for v in pair)
    return torch.nn.functional.pad(x, flat)

kernel_name = 'concat_heads__grouped_kv_mqa__ssm_conv_s4__prompt'

def setup_inputs():

    _w = (lambda a: (lambda t: t.to(torch.bfloat16) if t.is_floating_point() else t)(torch.as_tensor(a)))
    def _A_setup():
        B, S, D, H = 1, 2048, 576, 32
        Dh = D // H
        return {
            "x": _w((lambda *s: torch.randn(*s, dtype=torch.bfloat16) * 0.05)(B, S, D)),
            "wq": _w((lambda *s: torch.randn(*s, dtype=torch.bfloat16) * 0.8)(D, H * Dh)),
            "wk": _w((lambda *s: torch.randn(*s, dtype=torch.bfloat16) * 0.8)(D, Dh)),
            "wv": _w((lambda *s: torch.randn(*s, dtype=torch.bfloat16) * 0.05)(D, Dh)),
            "wo": _w((lambda *s: torch.randn(*s, dtype=torch.bfloat16) * 0.05)(H * Dh, D)),
        }
    _A_in = _A_setup()

    def _B_setup():
        B, L, D, N = 1, 2048, 576, 128
        A_re = -(lambda _x: torch.exp(torch.as_tensor(_x)))((lambda *s: torch.randn(*s, dtype=torch.bfloat16) * 6.4)(D, N))
        A_im = torch.pi * (lambda *s: torch.randn(*s, dtype=torch.bfloat16) * 0.05)(D, N)
        B_re = (lambda *s: torch.randn(*s, dtype=torch.bfloat16) * 0.05)(D, N)
        B_im = (lambda *s: torch.randn(*s, dtype=torch.bfloat16) * 0.05)(D, N)
        C_re = (lambda *s: torch.randn(*s, dtype=torch.bfloat16) * 0.05)(D, N)
        C_im = (lambda *s: torch.randn(*s, dtype=torch.bfloat16) * 0.05)(D, N)
        log_dt = (lambda *s: torch.randn(*s, dtype=torch.bfloat16) * 0.05)(D) * 0.5 - 4.0
        Dskip = (lambda *s: torch.randn(*s, dtype=torch.bfloat16) * 0.05)(D)
        return {
            "u": _w((lambda *s: torch.randn(*s, dtype=torch.bfloat16) * 0.05)(B, L, D)),
            "A_re": _w(A_re),
            "A_im": _w(A_im),
            "B_re": _w(B_re),
            "B_im": _w(B_im),
            "C_re": _w(C_re),
            "C_im": _w(C_im),
            "log_dt": _w(log_dt),
            "Dskip": _w(Dskip),
        }
    _B_in = _B_setup()

    return {
        "A_x": _A_in["x"],
        "A_wq": _A_in["wq"],
        "A_wk": _A_in["wk"],
        "A_wv": _A_in["wv"],
        "A_wo": _A_in["wo"],
        "B_u": _B_in["u"],
        "B_A_re": _B_in["A_re"],
        "B_A_im": _B_in["A_im"],
        "B_B_re": _B_in["B_re"],
        "B_B_im": _B_in["B_im"],
        "B_C_re": _B_in["C_re"],
        "B_C_im": _B_in["C_im"],
        "B_log_dt": _B_in["log_dt"],
        "B_Dskip": _B_in["Dskip"],
    }

def reference(A_x, A_wq, A_wk, A_wv, A_wo, B_u, B_A_re, B_A_im, B_B_re, B_B_im, B_C_re, B_C_im, B_log_dt, B_Dskip):
    def _A_ref(x, wq, wk, wv, wo):
        B, S, D = x.shape
        H = 32
        Dh = D // H
        q = (lambda x, *d: x.permute(*d))((x @ wq).reshape(B, S, H, Dh), 0, 2, 1, 3)
        k = x @ wk
        v = x @ wv
        scores = torch.einsum("bhqd,bkd->bhqk", q, k) * (Dh ** -0.5)
        p = _softmax(scores, axis=-1)
        o = torch.einsum("bhqk,bkd->bhqd", p, v)
        return (lambda x, *d: x.permute(*d))(o, 0, 2, 1, 3).reshape(B, S, H * Dh) @ wo

    def _B_ref(u, A_re, A_im, B_re, B_im, C_re, C_im, log_dt, Dskip):
        Bsz, L, D = u.shape
        dt = torch.exp(log_dt)[:, None]
        A = A_re + 1j * A_im
        Bc = B_re + 1j * B_im
        Cc = C_re + 1j * C_im
        logdA = dt * A
        dB = dt * Bc
        l = (lambda x, dt: x.to(dt))(torch.arange(L), A_re.dtype)
        P = torch.exp(logdA[:, :, None] * l[None, None, :])
        K = torch.einsum("dn,dnl,dn->dl", Cc, P, dB).real
        L2 = 2 * L
        Kp = _pad(K, ((0, 0), (0, L)))
        up = (lambda x, *d: x.permute(*d))(u, 0, 2, 1)
        up = _pad(up, ((0, 0), (0, 0), (0, L)))
        Kf = (lambda x, axes=(-2,-1): torch.fft.rfft2(x.float(), dim=axes))(Kp[:, None, :], axes=(-2, -1))
        Uf = (lambda x, axes=(-2,-1): torch.fft.rfft2(x.float(), dim=axes))(up[:, :, None, :], axes=(-2, -1))
        Yf = Uf * Kf[None, :, :, :]
        y = (lambda x, s, axes=(-2,-1): torch.fft.irfft2(x, s=s, dim=axes).to(torch.bfloat16))(Yf, (1, L2), axes=(-2, -1))[:, :, 0, :L]
        y = (lambda x, *d: x.permute(*d))(y, 0, 2, 1) + u * Dskip[None, None, :]
        return y

    a = _A_ref(A_x, A_wq, A_wk, A_wv, A_wo)
    b = _B_ref(B_u, B_A_re, B_A_im, B_B_re, B_B_im, B_C_re, B_C_im, B_log_dt, B_Dskip)
    return torch.concatenate([a, b], axis=-1)
```

```asm
; @launch grid=(256,1,1) block=(512,1,1) lds=163840
.amdgcn_target "amdgcn-amd-amdhsa--gfx950"
.text
.globl concat_heads__grouped_kv_mqa__ssm_conv_s4__prompt_kernel
.p2align 8
.type concat_heads__grouped_kv_mqa__ssm_conv_s4__prompt_kernel,@function
concat_heads__grouped_kv_mqa__ssm_conv_s4__prompt_kernel:
    s_cmp_ge_u32 s2, 256
    s_cbranch_scc1 L_exit
    s_load_dwordx16 s[16:31], s[0:1], 0
    s_load_dwordx16 s[32:47], s[0:1], 64
    s_load_dwordx2 s[48:49], s[0:1], 128
    s_getpc_b64 s[82:83]
    v_lshrrev_b32 v2, 6, v0
    v_and_b32 v1, 63, v0
    v_readfirstlane_b32 s3, v2
    v_mov_b32 v254, 0
    v_mov_b32 v253, 163584
    s_and_b32 s53, s2, 7
    s_bfe_u32 s56, s2, 0x20003
    s_lshl_b32 s4, s53, 2
    s_add_u32 s4, s4, s56
    s_lshr_b32 s5, s2, 5
    s_lshr_b32 s80, s2, 6
    s_mul_i32 s81, s5, 144
    s_and_b32 s57, s5, 1
    s_lshl_b32 s78, s56, 1
    s_add_u32 s78, s78, s57
    s_sub_u32 s54, s3, 4
    s_cmp_lt_u32 s54, 3
    s_cbranch_scc1 L_h0
    v_lshrrev_b32 v2, 3, v1
    v_xor_b32 v2, v2, v1
    s_mul_i32 s54, s4, 73728
    v_lshl_add_u32 v15, v2, 4, s54
    s_mul_i32 s55, s80, 18432
    s_cmp_eq_u32 s3, 7
    s_cbranch_scc1 L_loader
    s_cmp_lg_u32 s3, s80
    s_cbranch_scc1 L_np0
    s_mul_i32 s57, s57, 9216
    s_add_u32 m0, s55, s57
    v_add_u32 v15, m0, v15
    s_waitcnt lgkmcnt(0)
    global_load_lds_dwordx4 v15, s[16:17] offset:0
    global_load_lds_dwordx4 v15, s[16:17] offset:1024
    global_load_lds_dwordx4 v15, s[16:17] offset:2048
    s_add_u32 m0, m0, 3072
    v_add_u32 v15, 3072, v15
    global_load_lds_dwordx4 v15, s[16:17] offset:0
    global_load_lds_dwordx4 v15, s[16:17] offset:1024
    global_load_lds_dwordx4 v15, s[16:17] offset:2048
    s_add_u32 m0, m0, 3072
    v_add_u32 v15, 3072, v15
    global_load_lds_dwordx4 v15, s[16:17] offset:0
    global_load_lds_dwordx4 v15, s[16:17] offset:1024
    global_load_lds_dwordx4 v15, s[16:17] offset:2048
    s_branch L_a1
L_np0:
    s_xor_b32 s54, s3, s80
    s_cmp_lg_u32 s54, 1
    s_cbranch_scc1 L_a1
    s_bfe_u32 s57, s2, 0x40003
    s_lshl_b32 s57, s57, 11
    v_and_b32 v2, 15, v1
    v_lshl_add_u32 v2, v2, 7, s57
    v_min_u32 v2, 29488, v2
    global_load_dword v252, v2, s[82:83]
    v_lshl_add_u32 v2, v1, 2, v253
    ds_write_b32 v2, v254
    s_lshr_b32 s57, s2, 3
    s_mul_i32 s57, s57, 640
    v_min_u32 v2, 4, v1
    v_lshl_add_u32 v2, v2, 7, s57
    v_min_u32 v2, 18816, v2
    s_mul_i32 s57, s53, 18944
    s_add_u32 s57, s57, 3276800
    v_add_u32 v2, s57, v2
    s_waitcnt lgkmcnt(0)
    global_load_dword v251, v2, s[48:49] sc1
    s_branch L_a1
L_h0:
    s_lshl_b32 s6, s53, 5
    s_lshr_b32 s64, s2, 3
    s_add_u32 s6, s6, s64
    s_lshr_b32 s64, s6, 2
    s_and_b32 s52, s6, 3
    s_mul_i32 s65, s64, 9
    s_and_b32 s66, s64, 1
    s_lshl_b32 s50, s52, 1
    s_add_u32 s50, s50, s65
    s_add_u32 s50, s50, s66
    s_cmp_eq_u32 s66, 0
    s_cselect_b32 s51, 8, 0
    s_add_u32 s51, s51, s65
    s_sub_u32 s68, s3, 4
    s_add_u32 s55, s50, s54
    s_cmp_eq_u32 s54, 2
    s_cselect_b32 s55, s51, s55
    s_lshl_b32 s56, s55, 8
    v_lshl_add_u32 v3, v1, 2, s56
    s_lshl_b32 s56, s55, 1
    v_mov_b32 v11, s56
    s_waitcnt lgkmcnt(0)
    global_load_ushort v10, v11, s[40:41]
    global_load_ushort v11, v11, s[42:43]
    global_load_dword v4, v3, s[28:29]
    global_load_dword v5, v3, s[30:31]
    global_load_dword v6, v3, s[32:33]
    global_load_dword v7, v3, s[34:35]
    global_load_dword v8, v3, s[36:37]
    global_load_dword v9, v3, s[38:39]
    s_barrier
    s_branch L_kgen
L_loader:
    s_setprio 3
    v_add_u32 v2, 0, v1
    v_mul_u32_u24 v4, 21846, v2
    v_lshrrev_b32 v4, 16, v4
    v_mul_u32_u24 v5, 3, v4
    v_sub_u32 v5, v2, v5
    v_lshlrev_b32 v5, 4, v5
    v_min_u32 v5, 20, v5
    v_mad_u32_u24 v6, v4, 36, v5
    v_add_u32 v2, 64, v1
    v_mul_u32_u24 v4, 21846, v2
    v_lshrrev_b32 v4, 16, v4
    v_mul_u32_u24 v5, 3, v4
    v_sub_u32 v5, v2, v5
    v_lshlrev_b32 v5, 4, v5
    v_min_u32 v5, 20, v5
    v_mad_u32_u24 v7, v4, 36, v5
    v_add_u32 v2, 128, v1
    v_mul_u32_u24 v4, 21846, v2
    v_lshrrev_b32 v4, 16, v4
    v_mul_u32_u24 v5, 3, v4
    v_sub_u32 v5, v2, v5
    v_lshlrev_b32 v5, 4, v5
    v_min_u32 v5, 20, v5
    v_mad_u32_u24 v8, v4, 36, v5
    s_lshl_b32 s56, s53, 7
    s_add_u32 s56, s56, 3211264
    v_and_b32 v12, 31, v1
    v_lshl_add_u32 v13, v12, 2, s56
    s_mul_i32 s59, s78, 2304
    s_cmp_eq_u32 s57, 1
    s_waitcnt lgkmcnt(0)
    s_cselect_b32 s8, s22, s20
    s_cselect_b32 s9, s23, s21
    s_and_b32 s9, s9, 0xffff
    s_mov_b32 s10, 20736
    s_mov_b32 s11, 0x20000
    s_mov_b32 m0, 135424
    global_load_dword v16, v13, s[48:49] sc1
    s_barrier
L_wkl:
    buffer_load_dwordx4 v6, s[8:11], s59 offen lds
    s_add_u32 m0, m0, 1024
    s_nop 0
    buffer_load_dwordx4 v7, s[8:11], s59 offen lds
    s_add_u32 m0, m0, 1024
    s_nop 0
    buffer_load_dwordx4 v8, s[8:11], s59 offen lds
    s_add_u32 m0, m0, 1024
    s_add_u32 s59, s59, 2304
    s_cmp_eq_u32 s59, 20736
    s_cselect_b32 s59, 0, s59
    s_cmp_lt_u32 m0, 163072
    s_cbranch_scc1 L_wkl
    s_xor_b32 s57, s57, 1
    s_mul_i32 s57, s57, 9216
    s_add_u32 m0, s55, s57
    v_add_u32 v14, m0, v15
    global_load_lds_dwordx4 v14, s[16:17] offset:0
    global_load_lds_dwordx4 v14, s[16:17] offset:1024
    global_load_lds_dwordx4 v14, s[16:17] offset:2048
    s_add_u32 m0, m0, 3072
    v_add_u32 v14, 3072, v14
    global_load_lds_dwordx4 v14, s[16:17] offset:0
    global_load_lds_dwordx4 v14, s[16:17] offset:1024
    global_load_lds_dwordx4 v14, s[16:17] offset:2048
    s_add_u32 m0, m0, 3072
    v_add_u32 v14, 3072, v14
    global_load_lds_dwordx4 v14, s[16:17] offset:0
    global_load_lds_dwordx4 v14, s[16:17] offset:1024
    global_load_lds_dwordx4 v14, s[16:17] offset:2048
    s_mov_b32 m0, 163616
    s_mov_b64 exec, 1
    global_load_lds_dword v254, s[82:83]
    s_mov_b64 exec, -1
    s_mov_b32 s12, s18
    s_and_b32 s13, s19, 0xffff
    s_mov_b32 s14, 663552
    s_mov_b32 s15, 0x20000
    v_lshrrev_b32 v2, 3, v1
    v_and_b32 v3, 7, v1
    v_and_b32 v4, 2, v2
    v_xor_b32 v4, v3, v4
    v_lshlrev_b32 v4, 4, v4
    s_movk_i32 s54, 1152
    v_mad_u32_u24 v24, v2, s54, v4
    v_xor_b32 v25, 64, v24
    v_add_u32 v25, 9216, v25
    v_add_u32 v26, 18432, v24
    v_add_u32 v27, 18432, v25
    v_mul_u32_u24 v28, 1152, v1
    v_add_u32 v28, 128, v28
    s_mul_i32 s58, s78, 73728
    s_add_u32 s58, s58, s81
    s_add_u32 s60, s81, 663552
    s_add_u32 s59, s58, 36864
    s_mov_b32 m0, 121856
    s_nop 0
    buffer_load_dwordx4 v24, s[12:15], s58 offen lds
    s_mov_b32 m0, 122880
    s_nop 0
    buffer_load_dwordx4 v25, s[12:15], s58 offen lds
    s_mov_b32 m0, 123904
    s_nop 0
    buffer_load_dwordx4 v26, s[12:15], s58 offen lds
    s_mov_b32 m0, 124928
    s_nop 0
    buffer_load_dwordx4 v27, s[12:15], s58 offen lds
    s_mov_b32 m0, 117760
    s_nop 0
    buffer_load_dwordx4 v24, s[12:15], s59 offen lds
    s_mov_b32 m0, 118784
    s_nop 0
    buffer_load_dwordx4 v25, s[12:15], s59 offen lds
    s_mov_b32 m0, 119808
    s_nop 0
    buffer_load_dwordx4 v26, s[12:15], s59 offen lds
    s_mov_b32 m0, 120832
    s_nop 0
    buffer_load_dwordx4 v27, s[12:15], s59 offen lds
    s_mov_b32 m0, 125952
    s_nop 0
    buffer_load_dwordx4 v28, s[12:15], s58 offen lds
    s_mov_b32 m0, 163728
    s_mov_b64 exec, 1
    global_load_lds_dword v254, s[82:83]
    s_mov_b64 exec, -1
    s_add_u32 s58, s58, 73728
    s_cmp_eq_u32 s58, s60
    s_cselect_b32 s58, s81, s58
    s_add_u32 s59, s58, 36864
    s_mov_b32 m0, 113664
    s_nop 0
    buffer_load_dwordx4 v24, s[12:15], s58 offen lds
    s_mov_b32 m0, 114688
    s_nop 0
    buffer_load_dwordx4 v25, s[12:15], s58 offen lds
    s_mov_b32 m0, 115712
    s_nop 0
    buffer_load_dwordx4 v26, s[12:15], s58 offen lds
    s_mov_b32 m0, 116736
    s_nop 0
    buffer_load_dwordx4 v27, s[12:15], s58 offen lds
    s_mov_b32 m0, 109568
    s_nop 0
    buffer_load_dwordx4 v24, s[12:15], s59 offen lds
    s_mov_b32 m0, 110592
    s_nop 0
    buffer_load_dwordx4 v25, s[12:15], s59 offen lds
    s_mov_b32 m0, 111616
    s_nop 0
    buffer_load_dwordx4 v26, s[12:15], s59 offen lds
    s_mov_b32 m0, 112640
    s_nop 0
    buffer_load_dwordx4 v27, s[12:15], s59 offen lds
    s_mov_b32 m0, 126976
    s_nop 0
    buffer_load_dwordx4 v28, s[12:15], s58 offen lds
    s_mov_b32 m0, 163732
    s_mov_b64 exec, 1
    global_load_lds_dword v254, s[82:83]
    s_mov_b64 exec, -1
    s_add_u32 s58, s58, 73728
    s_cmp_eq_u32 s58, s60
    s_cselect_b32 s58, s81, s58
    s_mov_b32 s61, 3
L_xo:
    s_add_u32 s55, s55, 18432
    s_cmp_eq_u32 s55, 73728
    s_cselect_b32 s55, 0, s55
    s_mov_b32 m0, s55
    v_add_u32 v14, s55, v15
    global_load_lds_dwordx4 v14, s[16:17] offset:0
    global_load_lds_dwordx4 v14, s[16:17] offset:1024
    global_load_lds_dwordx4 v14, s[16:17] offset:2048
    global_load_lds_dwordx4 v14, s[16:17] offset:3072
    s_add_u32 m0, m0, 4096
    v_add_u32 v14, 4096, v14
    global_load_lds_dwordx4 v14, s[16:17] offset:0
    global_load_lds_dwordx4 v14, s[16:17] offset:1024
    global_load_lds_dwordx4 v14, s[16:17] offset:2048
    global_load_lds_dwordx4 v14, s[16:17] offset:3072
    s_add_u32 m0, m0, 4096
    v_add_u32 v14, 4096, v14
    global_load_lds_dwordx4 v14, s[16:17] offset:0
    global_load_lds_dwordx4 v14, s[16:17] offset:1024
    global_load_lds_dwordx4 v14, s[16:17] offset:2048
    global_load_lds_dwordx4 v14, s[16:17] offset:3072
    s_add_u32 m0, m0, 4096
    v_add_u32 v14, 4096, v14
    global_load_lds_dwordx4 v14, s[16:17] offset:0
    global_load_lds_dwordx4 v14, s[16:17] offset:1024
    global_load_lds_dwordx4 v14, s[16:17] offset:2048
    global_load_lds_dwordx4 v14, s[16:17] offset:3072
    s_add_u32 m0, m0, 4096
    v_add_u32 v14, 4096, v14
    global_load_lds_dwordx4 v14, s[16:17] offset:0
    global_load_lds_dwordx4 v14, s[16:17] offset:1024
    s_sub_u32 s61, s61, 1
    s_cmp_lg_u32 s61, 0
    s_cbranch_scc1 L_xo
    s_mov_b32 m0, 163620
    s_mov_b64 exec, 1
    global_load_lds_dword v254, s[82:83]
    s_mov_b64 exec, -1
    s_lshl_b32 s6, s53, 5
    s_lshr_b32 s64, s2, 3
    s_add_u32 s6, s6, s64
    s_lshr_b32 s64, s6, 2
    s_and_b32 s52, s6, 3
    s_mul_i32 s65, s64, 9
    s_and_b32 s66, s64, 1
    s_lshl_b32 s50, s52, 1
    s_add_u32 s50, s50, s65
    s_add_u32 s50, s50, s66
    s_cmp_eq_u32 s66, 0
    s_cselect_b32 s51, 8, 0
    s_add_u32 s51, s51, s65
    s_sub_u32 s68, s3, 4
    s_add_u32 s59, s58, 36864
    s_mov_b32 m0, 105472
    s_nop 0
    buffer_load_dwordx4 v24, s[12:15], s58 offen lds
    s_mov_b32 m0, 106496
    s_nop 0
    buffer_load_dwordx4 v25, s[12:15], s58 offen lds
    s_mov_b32 m0, 107520
    s_nop 0
    buffer_load_dwordx4 v26, s[12:15], s58 offen lds
    s_mov_b32 m0, 108544
    s_nop 0
    buffer_load_dwordx4 v27, s[12:15], s58 offen lds
    s_mov_b32 m0, 101376
    s_nop 0
    buffer_load_dwordx4 v24, s[12:15], s59 offen lds
    s_mov_b32 m0, 102400
    s_nop 0
    buffer_load_dwordx4 v25, s[12:15], s59 offen lds
    s_mov_b32 m0, 103424
    s_nop 0
    buffer_load_dwordx4 v26, s[12:15], s59 offen lds
    s_mov_b32 m0, 104448
    s_nop 0
    buffer_load_dwordx4 v27, s[12:15], s59 offen lds
    s_mov_b32 m0, 128000
    s_nop 0
    buffer_load_dwordx4 v28, s[12:15], s58 offen lds
    s_mov_b32 m0, 163736
    s_mov_b64 exec, 1
    global_load_lds_dword v254, s[82:83]
    s_mov_b64 exec, -1
    s_add_u32 s58, s58, 73728
    s_cmp_eq_u32 s58, s60
    s_cselect_b32 s58, s81, s58
    v_lshlrev_b32 v252, 4, v1
    v_and_b32 v200, 3, v1
    v_lshl_add_u32 v250, v200, 2, v253
    v_subrev_u32 v200, 256, v0
    v_lshrrev_b32 v200, 1, v200
    v_mul_u32_u24 v201, 1152, v200
    s_lshl_b32 s64, s50, 1
    s_and_b32 s65, s51, -2
    s_lshl_b32 s65, s65, 1
    s_sub_u32 s65, s65, s64
    v_and_b32 v202, 1, v1
    v_mul_lo_u32 v203, v202, s65
    v_add3_u32 v251, v201, v203, s64
    v_mul_u32_u24 v203, 9216, v202
    v_lshlrev_b32 v200, 1, v200
    v_sub_u32 v200, v203, v200
    v_add_u32 v200, 29054, v200
    s_lshl_b32 s72, s6, 1
    s_add_u32 s64, s72, 0
    s_and_b32 s64, s64, 15
    s_lshl_b32 s64, s64, 8
    v_subrev_u32 v210, s64, v200
    s_add_u32 s64, s72, 1
    s_and_b32 s64, s64, 15
    s_lshl_b32 s64, s64, 8
    v_subrev_u32 v211, s64, v200
    s_add_u32 s64, s72, 2
    s_and_b32 s64, s64, 15
    s_lshl_b32 s64, s64, 8
    v_subrev_u32 v212, s64, v200
    s_add_u32 s64, s72, 3
    s_and_b32 s64, s64, 15
    s_lshl_b32 s64, s64, 8
    v_subrev_u32 v213, s64, v200
    s_add_u32 s64, s72, 4
    s_and_b32 s64, s64, 15
    s_lshl_b32 s64, s64, 8
    v_subrev_u32 v214, s64, v200
    s_add_u32 s64, s72, 5
    s_and_b32 s64, s64, 15
    s_lshl_b32 s64, s64, 8
    v_subrev_u32 v215, s64, v200
    s_add_u32 s64, s72, 6
    s_and_b32 s64, s64, 15
    s_lshl_b32 s64, s64, 8
    v_subrev_u32 v216, s64, v200
    s_add_u32 s64, s72, 7
    s_and_b32 s64, s64, 15
    s_lshl_b32 s64, s64, 8
    v_subrev_u32 v217, s64, v200
    s_add_u32 s59, s58, 36864
    s_mov_b32 m0, 97280
    s_nop 0
    buffer_load_dwordx4 v24, s[12:15], s58 offen lds
    s_mov_b32 m0, 98304
    s_nop 0
    buffer_load_dwordx4 v25, s[12:15], s58 offen lds
    s_mov_b32 m0, 99328
    s_nop 0
    buffer_load_dwordx4 v26, s[12:15], s58 offen lds
    s_mov_b32 m0, 100352
    s_nop 0
    buffer_load_dwordx4 v27, s[12:15], s58 offen lds
    s_mov_b32 m0, 93184
    s_nop 0
    buffer_load_dwordx4 v24, s[12:15], s59 offen lds
    s_mov_b32 m0, 94208
    s_nop 0
    buffer_load_dwordx4 v25, s[12:15], s59 offen lds
    s_mov_b32 m0, 95232
    s_nop 0
    buffer_load_dwordx4 v26, s[12:15], s59 offen lds
    s_mov_b32 m0, 96256
    s_nop 0
    buffer_load_dwordx4 v27, s[12:15], s59 offen lds
    s_mov_b32 m0, 129024
    s_nop 0
    buffer_load_dwordx4 v28, s[12:15], s58 offen lds
    s_mov_b32 m0, 163740
    s_mov_b64 exec, 1
    global_load_lds_dword v254, s[82:83]
    s_mov_b64 exec, -1
    s_add_u32 s58, s58, 73728
    s_cmp_eq_u32 s58, s60
    s_cselect_b32 s58, s81, s58
    s_add_u32 s64, s72, 8
    s_and_b32 s64, s64, 15
    s_lshl_b32 s64, s64, 8
    v_subrev_u32 v218, s64, v200
    s_add_u32 s64, s72, 9
    s_and_b32 s64, s64, 15
    s_lshl_b32 s64, s64, 8
    v_subrev_u32 v219, s64, v200
    s_add_u32 s64, s72, 10
    s_and_b32 s64, s64, 15
    s_lshl_b32 s64, s64, 8
    v_subrev_u32 v220, s64, v200
    s_add_u32 s64, s72, 11
    s_and_b32 s64, s64, 15
    s_lshl_b32 s64, s64, 8
    v_subrev_u32 v221, s64, v200
    s_add_u32 s64, s72, 12
    s_and_b32 s64, s64, 15
    s_lshl_b32 s64, s64, 8
    v_subrev_u32 v222, s64, v200
    s_add_u32 s64, s72, 13
    s_and_b32 s64, s64, 15
    s_lshl_b32 s64, s64, 8
    v_subrev_u32 v223, s64, v200
    s_add_u32 s64, s72, 14
    s_and_b32 s64, s64, 15
    s_lshl_b32 s64, s64, 8
    v_subrev_u32 v224, s64, v200
    s_add_u32 s64, s72, 15
    s_and_b32 s64, s64, 15
    s_lshl_b32 s64, s64, 8
    v_subrev_u32 v225, s64, v200
    v_bfe_u32 v203, v1, 1, 3
    v_lshlrev_b32 v203, 4, v203
    v_lshl_add_u32 v203, v202, 2, v203
    s_lshl_b32 s64, s4, 7
    s_and_b32 s65, s68, 2
    s_lshl_b32 s65, s65, 2
    s_add_u32 s64, s64, s65
    s_add_u32 s64, s64, 3145728
    v_add_u32 v236, s64, v203
    v_and_b32 v204, 15, v1
    v_lshrrev_b32 v205, 4, v1
    v_add_u32 v206, 1, v204
    v_and_b32 v207, 1, v206
    v_mul_u32_u24 v207, 4158, v207
    v_lshl_add_u32 v206, v206, 1, v207
    v_lshl_add_u32 v206, v205, 4, v206
    v_lshlrev_b32 v207, 5, v204
    v_sub_u32 v207, 25440, v207
    v_lshl_add_u32 v207, v205, 4, v207
    s_add_u32 s59, s58, 36864
    s_mov_b32 m0, 89088
    s_nop 0
    buffer_load_dwordx4 v24, s[12:15], s58 offen lds
    s_mov_b32 m0, 90112
    s_nop 0
    buffer_load_dwordx4 v25, s[12:15], s58 offen lds
    s_mov_b32 m0, 91136
    s_nop 0
    buffer_load_dwordx4 v26, s[12:15], s58 offen lds
    s_mov_b32 m0, 92160
    s_nop 0
    buffer_load_dwordx4 v27, s[12:15], s58 offen lds
    s_mov_b32 m0, 84992
    s_nop 0
    buffer_load_dwordx4 v24, s[12:15], s59 offen lds
    s_mov_b32 m0, 86016
    s_nop 0
    buffer_load_dwordx4 v25, s[12:15], s59 offen lds
    s_mov_b32 m0, 87040
    s_nop 0
    buffer_load_dwordx4 v26, s[12:15], s59 offen lds
    s_mov_b32 m0, 88064
    s_nop 0
    buffer_load_dwordx4 v27, s[12:15], s59 offen lds
    s_mov_b32 m0, 130048
    s_nop 0
    buffer_load_dwordx4 v28, s[12:15], s58 offen lds
    s_mov_b32 m0, 163744
    s_mov_b64 exec, 1
    global_load_lds_dword v254, s[82:83]
    s_mov_b64 exec, -1
    s_add_u32 s58, s58, 73728
    s_cmp_eq_u32 s58, s60
    s_cselect_b32 s58, s81, s58
    s_lshr_b32 s64, s68, 1
    s_and_b32 s65, s68, 1
    s_lshl_b32 s65, s65, 8
    s_mul_i32 s66, s64, 8320
    s_add_u32 s66, s66, s65
    v_add_u32 v226, s66, v206
    s_mul_i32 s66, s64, 4608
    s_add_u32 s66, s66, s65
    v_add_u32 v243, s66, v207
    s_lshl_b32 s65, s68, 7
    s_add_u32 s66, s65, 16640
    v_add_u32 v230, s66, v206
    s_and_b32 s66, s51, 1
    s_add_u32 s66, s66, 2
    s_mul_i32 s66, s66, 4608
    s_add_u32 s66, s66, s65
    v_add_u32 v242, s66, v207
    v_add_u32 v227, 1024, v226
    v_add_u32 v231, 1024, v230
    v_add_u32 v228, 2048, v226
    v_add_u32 v232, 2048, v230
    v_add_u32 v229, 3072, v226
    v_add_u32 v233, 3072, v230
    s_add_u32 s59, s58, 36864
    s_mov_b32 m0, 80896
    s_nop 0
    buffer_load_dwordx4 v24, s[12:15], s58 offen lds
    s_mov_b32 m0, 81920
    s_nop 0
    buffer_load_dwordx4 v25, s[12:15], s58 offen lds
    s_mov_b32 m0, 82944
    s_nop 0
    buffer_load_dwordx4 v26, s[12:15], s58 offen lds
    s_mov_b32 m0, 83968
    s_nop 0
    buffer_load_dwordx4 v27, s[12:15], s58 offen lds
    s_mov_b32 m0, 76800
    s_nop 0
    buffer_load_dwordx4 v24, s[12:15], s59 offen lds
    s_mov_b32 m0, 77824
    s_nop 0
    buffer_load_dwordx4 v25, s[12:15], s59 offen lds
    s_mov_b32 m0, 78848
    s_nop 0
    buffer_load_dwordx4 v26, s[12:15], s59 offen lds
    s_mov_b32 m0, 79872
    s_nop 0
    buffer_load_dwordx4 v27, s[12:15], s59 offen lds
    s_mov_b32 m0, 131072
    s_nop 0
    buffer_load_dwordx4 v28, s[12:15], s58 offen lds
    s_mov_b32 m0, 163748
    s_mov_b64 exec, 1
    global_load_lds_dword v254, s[82:83]
    s_mov_b64 exec, -1
    s_add_u32 s58, s58, 73728
    s_cmp_eq_u32 s58, s60
    s_cselect_b32 s58, s81, s58
    s_lshl_b32 s64, s68, 13
    s_add_u32 s64, s64, 43392
    v_add_u32 v241, s64, v252
    s_lshl_b32 s64, s68, 11
    s_add_u32 s64, s64, 43392
    v_add_u32 v239, s64, v252
    v_add_u32 v240, 32768, v239
    s_lshr_b32 s64, s68, 1
    s_and_b32 s65, s68, 1
    s_lshl_b32 s66, s64, 10
    s_lshl_b32 s67, s65, 3
    s_add_u32 s66, s66, s67
    s_add_u32 s66, s66, 76160
    v_add_u32 v238, s66, v252
    v_lshlrev_b32 v206, 4, v204
    v_lshl_add_u32 v206, v205, 2, v206
    v_mul_u32_u24 v237, 2304, v206
    s_sub_u32 s66, 7, s52
    s_cmp_eq_u32 s64, 0
    s_cselect_b32 s66, s52, s66
    s_mul_i32 s70, s66, 589824
    s_mul_i32 s66, s65, 4608
    s_add_u32 s70, s70, s66
    s_lshl_b32 s66, s51, 1
    s_add_u32 s70, s70, s66
    s_add_u32 s70, s70, 1152
    s_mul_i32 s69, s68, 1179648
    s_lshl_b32 s66, s50, 1
    s_add_u32 s69, s69, s66
    s_add_u32 s69, s69, 1152
Lspin_1:
    ds_read_b32 v2, v253 offset:0
    s_waitcnt lgkmcnt(0)
    v_cmp_gt_u32 vcc, 4, v2
    s_cbranch_vccnz Lspin_1
    ds_read_b32 v2, v253 offset:24
    s_waitcnt lgkmcnt(0)
    v_readfirstlane_b32 s7, v2
    s_getreg_b32 s79, hwreg(HW_REG_XCC_ID, 0, 4)
    s_add_u32 s79, s79, 1
    s_mul_i32 s79, s79, 0x01010101
    s_xor_b32 s79, s79, s7
    s_add_u32 s59, s58, 36864
    s_mov_b32 m0, 72704
    s_nop 0
    buffer_load_dwordx4 v24, s[12:15], s58 offen lds
    s_mov_b32 m0, 73728
    s_nop 0
    buffer_load_dwordx4 v25, s[12:15], s58 offen lds
    s_mov_b32 m0, 74752
    s_nop 0
    buffer_load_dwordx4 v26, s[12:15], s58 offen lds
    s_mov_b32 m0, 75776
    s_nop 0
    buffer_load_dwordx4 v27, s[12:15], s58 offen lds
    s_mov_b32 m0, 68608
    s_nop 0
    buffer_load_dwordx4 v24, s[12:15], s59 offen lds
    s_mov_b32 m0, 69632
    s_nop 0
    buffer_load_dwordx4 v25, s[12:15], s59 offen lds
    s_mov_b32 m0, 70656
    s_nop 0
    buffer_load_dwordx4 v26, s[12:15], s59 offen lds
    s_mov_b32 m0, 71680
    s_nop 0
    buffer_load_dwordx4 v27, s[12:15], s59 offen lds
    s_mov_b32 m0, 132096
    s_nop 0
    buffer_load_dwordx4 v28, s[12:15], s58 offen lds
    s_mov_b32 m0, 163752
    s_mov_b64 exec, 1
    global_load_lds_dword v254, s[82:83]
    s_mov_b64 exec, -1
    s_add_u32 s58, s58, 73728
    s_cmp_eq_u32 s58, s60
    s_cselect_b32 s58, s81, s58
    v_lshrrev_b32 v200, 3, v1
    v_and_b32 v201, 7, v1
    v_and_b32 v202, 2, v200
    v_xor_b32 v202, v201, v202
    v_lshlrev_b32 v202, 4, v202
    s_movk_i32 s64, 1152
    v_mad_u32_u24 v244, v200, s64, v202
    v_xor_b32 v245, 64, v244
    v_mul_u32_u24 v203, 9, v200
    v_and_b32 v206, 1, v200
    v_lshlrev_b32 v206, 3, v206
    v_sub_u32 v203, v203, v206
    v_mad_u32_u24 v246, v203, s64, v202
    v_xor_b32 v247, 64, v246
    v_mad_u32_u24 v203, v205, 18, v204
    v_mul_u32_u24 v248, 1152, v203
    v_mul_u32_u24 v203, 9, v201
    v_and_b32 v206, 1, v201
    v_lshlrev_b32 v206, 3, v206
    v_sub_u32 v203, v203, v206
    v_mul_u32_u24 v249, 1152, v203
    s_mul_i32 s73, s68, 165888
    s_add_u32 s73, s73, s81
    s_mul_i32 s74, s68, 2304
    s_add_u32 s59, s58, 36864
    s_mov_b32 m0, 64512
    s_nop 0
    buffer_load_dwordx4 v24, s[12:15], s58 offen lds
    s_mov_b32 m0, 65536
    s_nop 0
    buffer_load_dwordx4 v25, s[12:15], s58 offen lds
    s_mov_b32 m0, 66560
    s_nop 0
    buffer_load_dwordx4 v26, s[12:15], s58 offen lds
    s_mov_b32 m0, 67584
    s_nop 0
    buffer_load_dwordx4 v27, s[12:15], s58 offen lds
    s_mov_b32 m0, 60416
    s_nop 0
    buffer_load_dwordx4 v24, s[12:15], s59 offen lds
    s_mov_b32 m0, 61440
    s_nop 0
    buffer_load_dwordx4 v25, s[12:15], s59 offen lds
    s_mov_b32 m0, 62464
    s_nop 0
    buffer_load_dwordx4 v26, s[12:15], s59 offen lds
    s_mov_b32 m0, 63488
    s_nop 0
    buffer_load_dwordx4 v27, s[12:15], s59 offen lds
    s_mov_b32 m0, 133120
    s_nop 0
    buffer_load_dwordx4 v28, s[12:15], s58 offen lds
    s_mov_b32 m0, 163756
    s_mov_b64 exec, 1
    global_load_lds_dword v254, s[82:83]
    s_mov_b64 exec, -1
    s_add_u32 s58, s58, 73728
    s_cmp_eq_u32 s58, s60
    s_cselect_b32 s58, s81, s58
    s_lshl_b32 s64, s4, 2
    s_add_u32 s64, s64, s68
    s_mul_i32 s71, s64, 36864
    s_add_u32 s71, s71, s81
    s_mul_i32 s64, s64, 18432
    s_add_u32 s64, s64, 331776
    v_add_u32 v235, s64, v252
    v_mul_u32_u24 v200, 160, v204
    v_lshl_add_u32 v200, v205, 3, v200
    s_mul_i32 s64, s68, 2560
    s_add_u32 s64, s64, 87808
    v_add_u32 v234, s64, v200
    v_add_u32 v200, 0, v1
    v_mul_u32_u24 v201, 7282, v200
    v_lshrrev_b32 v201, 16, v201
    v_add_u32 v202, v200, v201
    v_lshl_add_u32 v190, v202, 4, s64
    v_mul_u32_u24 v201, 135, v201
    v_add_lshl_u32 v193, v200, v201, 4
    v_add_u32 v200, 64, v1
    v_mul_u32_u24 v201, 7282, v200
    v_lshrrev_b32 v201, 16, v201
    v_add_u32 v202, v200, v201
    v_lshl_add_u32 v191, v202, 4, s64
    v_mul_u32_u24 v201, 135, v201
    v_add_lshl_u32 v194, v200, v201, 4
    v_add_u32 v200, 128, v1
    v_mul_u32_u24 v201, 7282, v200
    v_lshrrev_b32 v201, 16, v201
    v_add_u32 v202, v200, v201
    v_lshl_add_u32 v192, v202, 4, s64
    v_mul_u32_u24 v201, 135, v201
    v_add_lshl_u32 v195, v200, v201, 4
    s_add_u32 s59, s58, 36864
    s_mov_b32 m0, 56320
    s_nop 0
    buffer_load_dwordx4 v24, s[12:15], s58 offen lds
    s_mov_b32 m0, 57344
    s_nop 0
    buffer_load_dwordx4 v25, s[12:15], s58 offen lds
    s_mov_b32 m0, 58368
    s_nop 0
    buffer_load_dwordx4 v26, s[12:15], s58 offen lds
    s_mov_b32 m0, 59392
    s_nop 0
    buffer_load_dwordx4 v27, s[12:15], s58 offen lds
    s_mov_b32 m0, 52224
    s_nop 0
    buffer_load_dwordx4 v24, s[12:15], s59 offen lds
    s_mov_b32 m0, 53248
    s_nop 0
    buffer_load_dwordx4 v25, s[12:15], s59 offen lds
    s_mov_b32 m0, 54272
    s_nop 0
    buffer_load_dwordx4 v26, s[12:15], s59 offen lds
    s_mov_b32 m0, 55296
    s_nop 0
    buffer_load_dwordx4 v27, s[12:15], s59 offen lds
    s_mov_b32 m0, 134144
    s_nop 0
    buffer_load_dwordx4 v28, s[12:15], s58 offen lds
    s_mov_b32 m0, 163760
    s_mov_b64 exec, 1
    global_load_lds_dword v254, s[82:83]
    s_mov_b64 exec, -1
    s_add_u32 s58, s58, 73728
    s_cmp_eq_u32 s58, s60
    s_cselect_b32 s58, s81, s58
    s_mov_b32 s54, 0
L_pk0:
    global_load_dword v16, v13, s[48:49] sc1
    s_add_u32 s54, s54, 1
    s_waitcnt vmcnt(0)
    v_cmp_ne_u32 vcc, s79, v16
    s_cmp_gt_u32 s54, 24
    s_cbranch_scc1 L_pk0_d
    s_cbranch_vccnz L_pk0_s
L_pk0_d:
    s_mov_b32 s58, 3276800
    s_cbranch_vccnz L_pkg
    s_mov_b32 m0, 163612
    s_mov_b64 exec, 1
    global_load_lds_dword v254, s[82:83]
    s_mov_b64 exec, -1
L_pkd:
    s_add_u32 s55, s53, 0
    s_and_b32 s55, s55, 7
    s_mul_i32 s55, s55, 18944
    s_add_u32 s55, s55, s58
    s_add_u32 s56, s48, s55
    s_addc_u32 s57, s49, 0
    s_mov_b32 m0, 144640
Lch_2:
    s_nop 0
    global_load_lds_dwordx4 v252, s[56:57] offset:0 sc1
    global_load_lds_dwordx4 v252, s[56:57] offset:1024 sc1
    global_load_lds_dwordx4 v252, s[56:57] offset:2048 sc1
    s_add_u32 s56, s56, 3072
    s_addc_u32 s57, s57, 0
    s_add_u32 m0, m0, 3072
    s_cmp_lt_u32 m0, 163072
    s_cbranch_scc1 Lch_2
    s_mov_b32 exec_hi, 0
    global_load_lds_dwordx4 v252, s[56:57] sc1
    s_mov_b32 m0, 163680
    s_mov_b64 exec, 1
    global_load_lds_dword v254, s[82:83]
    s_mov_b64 exec, -1
    v_lshrrev_b32 v16, 5, v1
    v_add3_u32 v16, v16, s53, 1
    v_add_u32 v17, 0, v16
    v_and_b32 v17, 7, v17
    v_lshl_add_u32 v17, v17, 5, v12
    v_lshlrev_b32 v17, 7, v17
    v_add_u32 v20, 4096, v17
    v_add_u32 v17, 2, v16
    v_and_b32 v17, 7, v17
    v_lshl_add_u32 v17, v17, 5, v12
    v_lshlrev_b32 v17, 7, v17
    v_add_u32 v21, 4096, v17
    v_add_u32 v17, 4, v16
    v_and_b32 v17, 7, v17
    v_lshl_add_u32 v17, v17, 5, v12
    v_lshlrev_b32 v17, 7, v17
    v_add_u32 v22, 4096, v17
    v_add_u32 v17, 6, v16
    v_and_b32 v17, 7, v17
    v_lshl_add_u32 v17, v17, 5, v12
    v_lshlrev_b32 v17, 7, v17
    v_add_u32 v23, 4096, v17
    v_bfe_u32 v200, v1, 2, 2
    v_and_b32 v201, 3, v1
    v_lshrrev_b32 v202, 1, v200
    v_and_b32 v203, 1, v205
    v_lshl_or_b32 v202, v203, 1, v202
    v_lshl_add_u32 v200, v205, 3, v200
    v_lshlrev_b32 v203, 7, v200
    v_lshl_add_u32 v203, v201, 3, v203
    v_and_b32 v201, 1, v201
    v_lshlrev_b32 v201, 3, v201
    v_lshl_add_u32 v200, v200, 4, v201
    v_add_u32 v189, 73728, v200
    v_xor_b32 v200, 0, v202
    v_lshl_add_u32 v181, v200, 5, v203
    v_add_u32 v185, 36864, v181
    v_xor_b32 v200, 1, v202
    v_lshl_add_u32 v182, v200, 5, v203
    v_add_u32 v186, 36864, v182
    v_xor_b32 v200, 2, v202
    v_lshl_add_u32 v183, v200, 5, v203
    v_add_u32 v187, 36864, v183
    v_xor_b32 v200, 3, v202
    v_lshl_add_u32 v184, v200, 5, v203
    v_add_u32 v188, 36864, v184
    s_mov_b32 s54, 0
L_pk1:
    global_load_dword v30, v20, s[48:49] sc1
    s_add_u32 s54, s54, 1
    s_waitcnt vmcnt(0)
    v_cmp_ne_u32 vcc, s7, v30
    s_cmp_gt_u32 s54, 1048576
    s_cbranch_scc1 L_pk1_d
    s_cbranch_vccnz L_pk1_s
L_pk1_d:
Lspin_3:
    ds_read_b32 v2, v253 offset:8
    s_waitcnt lgkmcnt(0)
    v_cmp_gt_u32 vcc, 4, v2
    s_cbranch_vccnz Lspin_3_s
    s_add_u32 s55, s53, 1
    s_and_b32 s55, s55, 7
    s_mul_i32 s55, s55, 18944
    s_add_u32 s55, s55, 131072
    s_add_u32 s56, s48, s55
    s_addc_u32 s57, s49, 0
    s_mov_b32 m0, 125696
Lch_4:
    s_nop 0
    global_load_lds_dwordx4 v252, s[56:57] offset:0 sc1
    global_load_lds_dwordx4 v252, s[56:57] offset:1024 sc1
    global_load_lds_dwordx4 v252, s[56:57] offset:2048 sc1
    s_add_u32 s56, s56, 3072
    s_addc_u32 s57, s57, 0
    s_add_u32 m0, m0, 3072
    s_cmp_lt_u32 m0, 144128
    s_cbranch_scc1 Lch_4
    s_mov_b32 exec_hi, 0
    global_load_lds_dwordx4 v252, s[56:57] sc1
    s_mov_b32 m0, 163684
    s_mov_b64 exec, 1
    global_load_lds_dword v254, s[82:83]
    s_mov_b64 exec, -1
    s_add_u32 s55, s53, 2
    s_and_b32 s55, s55, 7
    s_mul_i32 s55, s55, 18944
    s_add_u32 s55, s55, 131072
    s_add_u32 s56, s48, s55
    s_addc_u32 s57, s49, 0
    s_mov_b32 m0, 49920
Lch_5:
    s_nop 0
    global_load_lds_dwordx4 v252, s[56:57] offset:0 sc1
    global_load_lds_dwordx4 v252, s[56:57] offset:1024 sc1
    global_load_lds_dwordx4 v252, s[56:57] offset:2048 sc1
    s_add_u32 s56, s56, 3072
    s_addc_u32 s57, s57, 0
    s_add_u32 m0, m0, 3072
    s_cmp_lt_u32 m0, 68352
    s_cbranch_scc1 Lch_5
    s_mov_b32 exec_hi, 0
    global_load_lds_dwordx4 v252, s[56:57] sc1
    s_mov_b32 m0, 163688
    s_mov_b64 exec, 1
    global_load_lds_dword v254, s[82:83]
    s_mov_b64 exec, -1
    s_mov_b32 s54, 0
L_pk2:
    global_load_dword v30, v21, s[48:49] sc1
    global_load_dword v31, v22, s[48:49] sc1
    global_load_dword v32, v23, s[48:49] sc1
    s_add_u32 s54, s54, 1
    s_waitcnt vmcnt(0)
    v_xor_b32 v30, s7, v30
    v_xor_b32 v31, s7, v31
    v_xor_b32 v32, s7, v32
    v_or_b32 v30, v30, v31
    v_or_b32 v30, v30, v32
    v_cmp_ne_u32 vcc, 0, v30
    s_cmp_gt_u32 s54, 1048576
    s_cbranch_scc1 L_pk2_d
    s_cbranch_vccnz L_pk2_s
L_pk2_d:
    s_add_u32 s55, s53, 3
    s_and_b32 s55, s55, 7
    s_mul_i32 s55, s55, 18944
    s_add_u32 s55, s55, 131072
    s_add_u32 s56, s48, s55
    s_addc_u32 s57, s49, 0
    s_mov_b32 m0, 68864
Lch_6:
    s_nop 0
    global_load_lds_dwordx4 v252, s[56:57] offset:0 sc1
    global_load_lds_dwordx4 v252, s[56:57] offset:1024 sc1
    global_load_lds_dwordx4 v252, s[56:57] offset:2048 sc1
    s_add_u32 s56, s56, 3072
    s_addc_u32 s57, s57, 0
    s_add_u32 m0, m0, 3072
    s_cmp_lt_u32 m0, 87296
    s_cbranch_scc1 Lch_6
    s_mov_b32 exec_hi, 0
    global_load_lds_dwordx4 v252, s[56:57] sc1
    s_mov_b32 m0, 163692
    s_mov_b64 exec, 1
    global_load_lds_dword v254, s[82:83]
    s_mov_b64 exec, -1
    s_add_u32 s55, s53, 4
    s_and_b32 s55, s55, 7
    s_mul_i32 s55, s55, 18944
    s_add_u32 s55, s55, 131072
    s_add_u32 s56, s48, s55
    s_addc_u32 s57, s49, 0
    s_mov_b32 m0, 87808
Lch_7:
    s_nop 0
    global_load_lds_dwordx4 v252, s[56:57] offset:0 sc1
    global_load_lds_dwordx4 v252, s[56:57] offset:1024 sc1
    global_load_lds_dwordx4 v252, s[56:57] offset:2048 sc1
    s_add_u32 s56, s56, 3072
    s_addc_u32 s57, s57, 0
    s_add_u32 m0, m0, 3072
    s_cmp_lt_u32 m0, 106240
    s_cbranch_scc1 Lch_7
    s_mov_b32 exec_hi, 0
    global_load_lds_dwordx4 v252, s[56:57] sc1
    s_mov_b32 m0, 163696
    s_mov_b64 exec, 1
    global_load_lds_dword v254, s[82:83]
    s_mov_b64 exec, -1
    s_add_u32 s55, s53, 5
    s_and_b32 s55, s55, 7
    s_mul_i32 s55, s55, 18944
    s_add_u32 s55, s55, 131072
    s_add_u32 s56, s48, s55
    s_addc_u32 s57, s49, 0
    s_mov_b32 m0, 106752
Lch_8:
    s_nop 0
    global_load_lds_dwordx4 v252, s[56:57] offset:0 sc1
    global_load_lds_dwordx4 v252, s[56:57] offset:1024 sc1
    global_load_lds_dwordx4 v252, s[56:57] offset:2048 sc1
    s_add_u32 s56, s56, 3072
    s_addc_u32 s57, s57, 0
    s_add_u32 m0, m0, 3072
    s_cmp_lt_u32 m0, 125184
    s_cbranch_scc1 Lch_8
    s_mov_b32 exec_hi, 0
    global_load_lds_dwordx4 v252, s[56:57] sc1
    s_mov_b32 m0, 163700
    s_mov_b64 exec, 1
    global_load_lds_dword v254, s[82:83]
    s_mov_b64 exec, -1
    s_branch L_ssm
L_pkg:
    s_lshl_b32 s54, s53, 12
    s_add_u32 s54, s54, 4096
    v_lshl_add_u32 v13, v12, 7, s54
    s_mov_b32 s54, 0
L_pk0g:
    global_load_dword v16, v13, s[48:49] sc1
    s_add_u32 s54, s54, 1
    s_waitcnt vmcnt(0)
    v_cmp_ne_u32 vcc, s7, v16
    s_cmp_gt_u32 s54, 1048576
    s_cbranch_scc1 L_pk0g_d
    s_cbranch_vccnz L_pk0g_s
L_pk0g_d:
    s_mov_b32 s58, 131072
    s_branch L_pkd
L_pk0_s:
    s_sleep 1
    s_branch L_pk0
L_pk1_s:
    s_sleep 2
    s_branch L_pk1
Lspin_3_s:
    s_sleep 1
    s_branch Lspin_3
L_pk2_s:
    s_sleep 2
    s_branch L_pk2
L_pk0g_s:
    s_sleep 2
    s_branch L_pk0g
L_a1:
    s_waitcnt lgkmcnt(0)
    s_barrier
    s_setprio 2
    s_cmp_lg_u32 s80, s3
    s_cbranch_scc1 L_a2
    s_load_dword s7, s[48:49], 0
L_a2:
    v_and_b32 v2, 15, v1
    v_lshrrev_b32 v3, 4, v1
    s_mul_i32 s55, s3, 18432
    s_movk_i32 s54, 1152
    v_mov_b32 v4, s55
    v_mad_u32_u24 v4, v2, s54, v4
    s_mov_b32 s56, s78
    v_add_u32 v5, s56, v2
    v_and_b32 v5, 7, v5
    v_xor_b32 v5, v5, v3
    s_lshl_b32 s57, s56, 7
    v_lshl_add_u32 v5, v5, 4, v4
    v_add_u32 v180, s57, v5
    v_xor_b32 v181, 64, v180
    s_add_u32 s56, s56, 1
    s_cmp_eq_u32 s56, 9
    s_cselect_b32 s56, 0, s56
    v_add_u32 v5, s56, v2
    v_and_b32 v5, 7, v5
    v_xor_b32 v5, v5, v3
    s_lshl_b32 s57, s56, 7
    v_lshl_add_u32 v5, v5, 4, v4
    v_add_u32 v182, s57, v5
    v_xor_b32 v183, 64, v182
    s_add_u32 s56, s56, 1
    s_cmp_eq_u32 s56, 9
    s_cselect_b32 s56, 0, s56
    v_add_u32 v5, s56, v2
    v_and_b32 v5, 7, v5
    v_xor_b32 v5, v5, v3
    s_lshl_b32 s57, s56, 7
    v_lshl_add_u32 v5, v5, 4, v4
    v_add_u32 v184, s57, v5
    v_xor_b32 v185, 64, v184
    s_add_u32 s56, s56, 1
    s_cmp_eq_u32 s56, 9
    s_cselect_b32 s56, 0, s56
    v_add_u32 v5, s56, v2
    v_and_b32 v5, 7, v5
    v_xor_b32 v5, v5, v3
    s_lshl_b32 s57, s56, 7
    v_lshl_add_u32 v5, v5, 4, v4
    v_add_u32 v186, s57, v5
    v_xor_b32 v187, 64, v186
    s_add_u32 s56, s56, 1
    s_cmp_eq_u32 s56, 9
    s_cselect_b32 s56, 0, s56
    v_add_u32 v5, s56, v2
    v_and_b32 v5, 7, v5
    v_xor_b32 v5, v5, v3
    s_lshl_b32 s57, s56, 7
    v_lshl_add_u32 v5, v5, 4, v4
    v_add_u32 v188, s57, v5
    v_xor_b32 v189, 64, v188
    s_add_u32 s56, s56, 1
    s_cmp_eq_u32 s56, 9
    s_cselect_b32 s56, 0, s56
    v_add_u32 v5, s56, v2
    v_and_b32 v5, 7, v5
    v_xor_b32 v5, v5, v3
    s_lshl_b32 s57, s56, 7
    v_lshl_add_u32 v5, v5, 4, v4
    v_add_u32 v190, s57, v5
    v_xor_b32 v191, 64, v190
    s_add_u32 s56, s56, 1
    s_cmp_eq_u32 s56, 9
    s_cselect_b32 s56, 0, s56
    v_add_u32 v5, s56, v2
    v_and_b32 v5, 7, v5
    v_xor_b32 v5, v5, v3
    s_lshl_b32 s57, s56, 7
    v_lshl_add_u32 v5, v5, 4, v4
    v_add_u32 v192, s57, v5
    v_xor_b32 v193, 64, v192
    s_add_u32 s56, s56, 1
    s_cmp_eq_u32 s56, 9
    s_cselect_b32 s56, 0, s56
    v_add_u32 v5, s56, v2
    v_and_b32 v5, 7, v5
    v_xor_b32 v5, v5, v3
    s_lshl_b32 s57, s56, 7
    v_lshl_add_u32 v5, v5, 4, v4
    v_add_u32 v194, s57, v5
    v_xor_b32 v195, 64, v194
    s_add_u32 s56, s56, 1
    s_cmp_eq_u32 s56, 9
    s_cselect_b32 s56, 0, s56
    v_add_u32 v5, s56, v2
    v_and_b32 v5, 7, v5
    v_xor_b32 v5, v5, v3
    s_lshl_b32 s57, s56, 7
    v_lshl_add_u32 v5, v5, 4, v4
    v_add_u32 v196, s57, v5
    v_xor_b32 v197, 64, v196
    v_bfe_u32 v6, v1, 2, 2
    v_and_b32 v7, 3, v1
    v_lshrrev_b32 v8, 1, v6
    v_and_b32 v9, 1, v3
    v_lshl_or_b32 v8, v9, 1, v8
    v_lshl_add_u32 v6, v3, 3, v6
    v_lshlrev_b32 v9, 7, v6
    v_lshl_add_u32 v9, v7, 3, v9
    v_add_u32 v9, 52224, v9
    s_and_b32 s58, s3, 1
    s_lshl_b32 s56, s58, 1
    v_xor_b32 v8, s56, v8
    v_lshl_add_u32 v212, v8, 5, v9
    v_xor_b32 v213, 32, v212
    v_add_u32 v214, 36864, v212
    v_add_u32 v215, 36864, v213
    v_and_b32 v10, 1, v7
    v_lshlrev_b32 v10, 3, v10
    v_lshl_add_u32 v10, v6, 4, v10
    v_add_u32 v216, 125952, v10
    v_mul_u32_u24 v4, 144, v2
    v_lshl_add_u32 v4, v3, 3, v4
    s_mul_i32 s54, s3, 2304
    s_add_u32 s54, s54, 135424
    v_add_u32 v228, s54, v4
    s_lshl_b32 s56, s58, 6
    s_and_b32 s57, s3, 2
    s_mul_i32 s54, s57, 2304
    s_add_u32 s54, s54, 135424
    s_add_u32 s56, s56, s54
    v_add_u32 v227, s56, v4
    v_and_b32 v11, 31, v1
    v_lshrrev_b32 v12, 5, v1
    v_mul_u32_u24 v4, 144, v11
    s_mul_i32 s56, s58, 72
    s_add_u32 s54, s54, s56
    v_add_u32 v4, s54, v4
    v_mad_u32_u24 v226, v12, 36, v4
    v_lshl_add_u32 v225, v12, 4, v4
    s_lshl_b32 s56, s57, 1
    v_add_u32 v229, s56, v253
    v_lshlrev_b32 v219, 4, v1
    v_and_b32 v4, 19, v11
    v_bfe_u32 v5, v11, 2, 1
    v_lshl_or_b32 v4, v5, 3, v4
    v_bfe_u32 v5, v11, 3, 1
    v_lshl_or_b32 v4, v5, 2, v4
    v_mad_u32_u24 v4, v12, 18, v4
    v_and_b32 v5, 27, v11
    v_cmp_eq_u32 vcc, 18, v5
    v_mov_b32 v13, 36
    v_mov_b32 v233, 0xdddd
    v_cndmask_b32 v5, 37, v13, vcc
    v_cmp_gt_u32 vcc, 18, v11
    v_mov_b32 v246, 0
    v_mov_b32 v247, 0
    v_cndmask_b32 v4, v5, v4, vcc
    v_lshlrev_b32 v220, 4, v4
    v_add_u32 v220, 1024, v220
    v_add_u32 v217, 144640, v219
    v_add_u32 v218, 144640, v220
    v_mov_b32 v224, 163684
    s_lshl_b32 s54, s3, 2
    v_add_u32 v222, s54, v253
    s_mov_b32 s69, 0x44532104
    s_mov_b32 s68, 0
    v_and_b32 v4, 1, v3
    s_movk_i32 s54, 18432
    v_lshlrev_b32 v5, 4, v2
    v_mad_u32_u24 v4, v4, s54, v5
    s_lshl_b32 s54, s4, 2
    s_add_u32 s54, s54, s57
    s_mul_i32 s54, s54, 18432
    s_mul_i32 s56, s5, 2304
    s_add_u32 s54, s54, s56
    s_add_u32 s54, s54, 327680
    s_lshl_b32 s56, s58, 3
    s_add_u32 s56, s56, s54
    v_add_u32 v231, s56, v4
    s_lshl_b32 s56, s58, 10
    s_add_u32 s56, s56, s54
    v_lshl_add_u32 v4, v12, 8, v4
    v_add_u32 v230, s56, v4
    s_lshl_b32 s59, s4, 3
    s_add_u32 s59, s59, s5
    s_lshl_b32 s54, s59, 2
    s_add_u32 s54, s54, s3
    s_lshl_b32 s54, s54, 2
    s_add_u32 s54, s54, 3145728
    v_mov_b32 v232, s54
    s_lshl_b32 s54, s59, 7
    s_add_u32 s54, s54, 4096
    v_mov_b32 v238, s54
    s_mul_i32 s62, s58, -36864
    s_add_u32 s62, s62, 18432
    s_cmp_lg_u32 s80, s3
    s_cbranch_scc1 L_np
    s_setprio 3
    v_mul_u32_u24 v5, 48, v6
    v_add_u32 v5, 135424, v5
    v_lshl_add_u32 v242, v7, 3, v5
    v_add_u32 v243, 40, v5
    s_mul_i32 s55, s53, 18944
    s_add_u32 s55, s55, 131072
    s_and_b32 s56, s4, 3
    s_lshl_b32 s57, s56, 1
    s_lshr_b32 s54, s3, 1
    s_add_u32 s57, s57, s54
    s_mul_i32 s57, s57, 2240
    s_add_u32 s57, s57, s55
    v_and_b32 v13, 1, v3
    v_lshlrev_b32 v13, 3, v13
    v_lshl_add_u32 v13, v2, 4, v13
    v_lshl_add_u32 v4, v12, 9, v13
    s_lshl_b32 s54, s58, 8
    s_add_u32 s54, s54, s57
    v_add_u32 v234, s54, v4
    s_lshl_b32 s56, s56, 2
    s_lshl_b32 s54, s3, 8
    s_add_u32 s56, s56, s54
    s_add_u32 s56, s56, s55
    s_add_u32 s56, s56, 17920
    v_lshl_add_u32 v235, v2, 4, s56
    s_movk_i32 s54, 288
    v_mad_u32_u24 v4, v12, s54, v13
    s_mul_i32 s54, s58, 608
    s_add_u32 s57, s57, s54
    s_add_u32 s57, s57, 1024
    v_add_u32 v236, s57, v4
    v_cmp_eq_u32 vcc, 4, v2
    v_mov_b32 v4, 0x3f803f80
    s_nop 0
    v_cndmask_b32 v237, 0, v4, vcc
    s_waitcnt lgkmcnt(0)
    s_mul_i32 s7, s7, 0x9E3779B1
    s_add_u32 s7, s7, 0x632BE5AB
    v_mov_b32 v239, s7
    ds_write_b32 v253, v239 offset:24
    s_getreg_b32 s79, hwreg(HW_REG_XCC_ID, 0, 4)
    s_add_u32 s79, s79, 1
    s_mul_i32 s79, s79, 0x01010101
    s_xor_b32 s79, s79, s7
    s_lshl_b32 s54, s59, 2
    s_add_u32 s54, s54, 3211264
    v_mov_b32 v240, s54
    v_mov_b32 v241, s79
    s_add_u32 s60, s48, 3145728
    s_addc_u32 s61, s49, 0
    s_waitcnt vmcnt(0)
Lspin_9:
    ds_read_b32 v8, v253 offset:32
    s_waitcnt lgkmcnt(0)
    v_cmp_gt_u32 vcc, 1, v8
    s_cbranch_vccnz Lspin_9
    ds_read_b128 v[16:19], v180
    ds_read_b128 v[20:23], v181
    ds_read_b128 v[24:27], v182
    ds_read_b128 v[28:31], v183
    ds_read_b128 v[32:35], v184
    ds_read_b128 v[36:39], v185
    ds_read_b128 v[40:43], v186
    ds_read_b128 v[44:47], v187
    ds_read_b128 v[48:51], v188
    ds_read_b128 v[52:55], v189
    ds_read_b128 v[56:59], v190
    ds_read_b128 v[60:63], v191
    ds_read_b128 v[64:67], v192
    ds_read_b128 v[68:71], v193
    ds_read_b128 v[72:75], v194
    ds_read_b128 v[76:79], v195
    ds_read_b128 v[80:83], v196
    ds_read_b128 v[84:87], v197
    v_cmp_le_u32 vcc, 4, v2
    s_bitcmp1_b32 s5, 0
    s_cbranch_scc1 L_pv
    ds_read_b64_tr_b16 v[88:89], v242 offset:0
    ds_read_b64_tr_b16 v[90:91], v242 offset:192
    ds_read_b64_tr_b16 v[92:93], v243 offset:0
    ds_read_b64_tr_b16 v[94:95], v243 offset:192
    ds_read_b64_tr_b16 v[96:97], v242 offset:1536
    ds_read_b64_tr_b16 v[98:99], v242 offset:1728
    ds_read_b64_tr_b16 v[100:101], v243 offset:1536
    ds_read_b64_tr_b16 v[102:103], v243 offset:1728
    ds_read_b64_tr_b16 v[104:105], v242 offset:3072
    ds_read_b64_tr_b16 v[106:107], v242 offset:3264
    ds_read_b64_tr_b16 v[108:109], v243 offset:3072
    ds_read_b64_tr_b16 v[110:111], v243 offset:3264
    ds_read_b64_tr_b16 v[112:113], v242 offset:4608
    ds_read_b64_tr_b16 v[114:115], v242 offset:4800
    s_waitcnt lgkmcnt(10)
    v_mfma_f32_16x16x32_bf16 v[160:163], v[88:91], v[16:19], 0
    ds_read_b64_tr_b16 v[116:117], v243 offset:4608
    ds_read_b64_tr_b16 v[118:119], v243 offset:4800
    v_mfma_f32_16x16x32_bf16 v[164:167], v[92:95], v[16:19], 0
    ds_read_b64_tr_b16 v[88:89], v242 offset:6144
    ds_read_b64_tr_b16 v[90:91], v242 offset:6336
    s_waitcnt lgkmcnt(10)
    v_mfma_f32_16x16x32_bf16 v[160:163], v[96:99], v[20:23], v[160:163]
    ds_read_b64_tr_b16 v[92:93], v243 offset:6144
    ds_read_b64_tr_b16 v[94:95], v243 offset:6336
    v_mfma_f32_16x16x32_bf16 v[164:167], v[100:103], v[20:23], v[164:167]
    ds_read_b64_tr_b16 v[96:97], v242 offset:7680
    ds_read_b64_tr_b16 v[98:99], v242 offset:7872
    s_waitcnt lgkmcnt(10)
    v_mfma_f32_16x16x32_bf16 v[160:163], v[104:107], v[24:27], v[160:163]
    ds_read_b64_tr_b16 v[100:101], v243 offset:7680
    ds_read_b64_tr_b16 v[102:103], v243 offset:7872
    v_mfma_f32_16x16x32_bf16 v[164:167], v[108:111], v[24:27], v[164:167]
    ds_read_b64_tr_b16 v[104:105], v242 offset:9216
    ds_read_b64_tr_b16 v[106:107], v242 offset:9408
    s_waitcnt lgkmcnt(10)
    v_mfma_f32_16x16x32_bf16 v[160:163], v[112:115], v[28:31], v[160:163]
    ds_read_b64_tr_b16 v[108:109], v243 offset:9216
    ds_read_b64_tr_b16 v[110:111], v243 offset:9408
    v_mfma_f32_16x16x32_bf16 v[164:167], v[116:119], v[28:31], v[164:167]
    ds_read_b64_tr_b16 v[112:113], v242 offset:10752
    ds_read_b64_tr_b16 v[114:115], v242 offset:10944
    s_waitcnt lgkmcnt(10)
    v_mfma_f32_16x16x32_bf16 v[160:163], v[88:91], v[32:35], v[160:163]
    ds_read_b64_tr_b16 v[116:117], v243 offset:10752
    ds_read_b64_tr_b16 v[118:119], v243 offset:10944
    v_mfma_f32_16x16x32_bf16 v[164:167], v[92:95], v[32:35], v[164:167]
    ds_read_b64_tr_b16 v[88:89], v242 offset:12288
    ds_read_b64_tr_b16 v[90:91], v242 offset:12480
    s_waitcnt lgkmcnt(10)
    v_mfma_f32_16x16x32_bf16 v[160:163], v[96:99], v[36:39], v[160:163]
    ds_read_b64_tr_b16 v[92:93], v243 offset:12288
    ds_read_b64_tr_b16 v[94:95], v243 offset:12480
    v_mfma_f32_16x16x32_bf16 v[164:167], v[100:103], v[36:39], v[164:167]
    ds_read_b64_tr_b16 v[96:97], v242 offset:13824
    ds_read_b64_tr_b16 v[98:99], v242 offset:14016
    s_waitcnt lgkmcnt(10)
    v_mfma_f32_16x16x32_bf16 v[160:163], v[104:107], v[40:43], v[160:163]
    ds_read_b64_tr_b16 v[100:101], v243 offset:13824
    ds_read_b64_tr_b16 v[102:103], v243 offset:14016
    v_mfma_f32_16x16x32_bf16 v[164:167], v[108:111], v[40:43], v[164:167]
    ds_read_b64_tr_b16 v[104:105], v242 offset:15360
    ds_read_b64_tr_b16 v[106:107], v242 offset:15552
    s_waitcnt lgkmcnt(10)
    v_mfma_f32_16x16x32_bf16 v[160:163], v[112:115], v[44:47], v[160:163]
    ds_read_b64_tr_b16 v[108:109], v243 offset:15360
    ds_read_b64_tr_b16 v[110:111], v243 offset:15552
    v_mfma_f32_16x16x32_bf16 v[164:167], v[116:119], v[44:47], v[164:167]
    ds_read_b64_tr_b16 v[112:113], v242 offset:16896
    ds_read_b64_tr_b16 v[114:115], v242 offset:17088
    s_waitcnt lgkmcnt(10)
    v_mfma_f32_16x16x32_bf16 v[160:163], v[88:91], v[48:51], v[160:163]
    ds_read_b64_tr_b16 v[116:117], v243 offset:16896
    ds_read_b64_tr_b16 v[118:119], v243 offset:17088
    v_mfma_f32_16x16x32_bf16 v[164:167], v[92:95], v[48:51], v[164:167]
    ds_read_b64_tr_b16 v[88:89], v242 offset:18432
    ds_read_b64_tr_b16 v[90:91], v242 offset:18624
    s_waitcnt lgkmcnt(10)
    v_mfma_f32_16x16x32_bf16 v[160:163], v[96:99], v[52:55], v[160:163]
    ds_read_b64_tr_b16 v[92:93], v243 offset:18432
    ds_read_b64_tr_b16 v[94:95], v243 offset:18624
    v_mfma_f32_16x16x32_bf16 v[164:167], v[100:103], v[52:55], v[164:167]
    ds_read_b64_tr_b16 v[96:97], v242 offset:19968
    ds_read_b64_tr_b16 v[98:99], v242 offset:20160
    s_waitcnt lgkmcnt(10)
    v_mfma_f32_16x16x32_bf16 v[160:163], v[104:107], v[56:59], v[160:163]
    ds_read_b64_tr_b16 v[100:101], v243 offset:19968
    ds_read_b64_tr_b16 v[102:103], v243 offset:20160
    v_mfma_f32_16x16x32_bf16 v[164:167], v[108:111], v[56:59], v[164:167]
    ds_read_b64_tr_b16 v[104:105], v242 offset:21504
    ds_read_b64_tr_b16 v[106:107], v242 offset:21696
    s_waitcnt lgkmcnt(10)
    v_mfma_f32_16x16x32_bf16 v[160:163], v[112:115], v[60:63], v[160:163]
    ds_read_b64_tr_b16 v[108:109], v243 offset:21504
    ds_read_b64_tr_b16 v[110:111], v243 offset:21696
    v_mfma_f32_16x16x32_bf16 v[164:167], v[116:119], v[60:63], v[164:167]
    ds_read_b64_tr_b16 v[112:113], v242 offset:23040
    ds_read_b64_tr_b16 v[114:115], v242 offset:23232
    s_waitcnt lgkmcnt(10)
    v_mfma_f32_16x16x32_bf16 v[160:163], v[88:91], v[64:67], v[160:163]
    ds_read_b64_tr_b16 v[116:117], v243 offset:23040
    ds_read_b64_tr_b16 v[118:119], v243 offset:23232
    v_mfma_f32_16x16x32_bf16 v[164:167], v[92:95], v[64:67], v[164:167]
    ds_read_b64_tr_b16 v[88:89], v242 offset:24576
    ds_read_b64_tr_b16 v[90:91], v242 offset:24768
    s_waitcnt lgkmcnt(10)
    v_mfma_f32_16x16x32_bf16 v[160:163], v[96:99], v[68:71], v[160:163]
    ds_read_b64_tr_b16 v[92:93], v243 offset:24576
    ds_read_b64_tr_b16 v[94:95], v243 offset:24768
    v_mfma_f32_16x16x32_bf16 v[164:167], v[100:103], v[68:71], v[164:167]
    ds_read_b64_tr_b16 v[96:97], v242 offset:26112
    ds_read_b64_tr_b16 v[98:99], v242 offset:26304
    s_waitcnt lgkmcnt(10)
    v_mfma_f32_16x16x32_bf16 v[160:163], v[104:107], v[72:75], v[160:163]
    ds_read_b64_tr_b16 v[100:101], v243 offset:26112
    ds_read_b64_tr_b16 v[102:103], v243 offset:26304
    v_mfma_f32_16x16x32_bf16 v[164:167], v[108:111], v[72:75], v[164:167]
    s_waitcnt lgkmcnt(8)
    v_mfma_f32_16x16x32_bf16 v[160:163], v[112:115], v[76:79], v[160:163]
    v_mfma_f32_16x16x32_bf16 v[164:167], v[116:119], v[76:79], v[164:167]
    s_waitcnt lgkmcnt(4)
    v_mfma_f32_16x16x32_bf16 v[160:163], v[88:91], v[80:83], v[160:163]
    v_mfma_f32_16x16x32_bf16 v[164:167], v[92:95], v[80:83], v[164:167]
    s_waitcnt lgkmcnt(0)
    v_mfma_f32_16x16x32_bf16 v[160:163], v[96:99], v[84:87], v[160:163]
    v_mfma_f32_16x16x32_bf16 v[164:167], v[100:103], v[84:87], v[164:167]
    s_mov_b32 m0, 163588
    s_mov_b64 exec, 1
    global_load_lds_dword v254, s[82:83]
    s_mov_b64 exec, -1
    s_mov_b32 s54, 0x3eae1a93
    s_mov_b32 s55, 0x3eae1a93
    v_add_u32 v180, s62, v180
    v_add_u32 v181, s62, v181
    v_add_u32 v182, s62, v182
    v_add_u32 v183, s62, v183
    v_add_u32 v184, s62, v184
    v_add_u32 v185, s62, v185
    v_add_u32 v186, s62, v186
    v_add_u32 v187, s62, v187
    v_add_u32 v188, s62, v188
    v_add_u32 v189, s62, v189
    v_add_u32 v190, s62, v190
    v_add_u32 v191, s62, v191
    v_add_u32 v192, s62, v192
    v_add_u32 v193, s62, v193
    v_add_u32 v194, s62, v194
    v_add_u32 v195, s62, v195
    v_add_u32 v196, s62, v196
    v_add_u32 v197, s62, v197
    v_pk_mul_f32 v[160:161], v[160:161], s[54:55]
    v_pk_mul_f32 v[162:163], v[162:163], s[54:55]
    v_pk_mul_f32 v[166:167], v[166:167], s[54:55]
    v_cvt_pk_bf16_f32 v8, v160, v161
    v_cvt_pk_bf16_f32 v9, v162, v163
    v_cvt_pk_bf16_f32 v10, v166, v167
    global_store_dwordx2 v234, v[8:9], s[60:61]
    s_mov_b64 exec, 0xffff
    global_store_dword v235, v10, s[60:61]
    global_store_dword v235, v10, s[48:49] sc1
    s_mov_b64 exec, -1
    global_store_dwordx2 v234, v[8:9], s[48:49] sc1
    s_branch L_pub
L_pv:
    ds_read_b64_tr_b16 v[88:89], v242 offset:0
    ds_read_b64_tr_b16 v[90:91], v242 offset:192
    ds_read_b64_tr_b16 v[92:93], v243 offset:0
    ds_read_b64_tr_b16 v[94:95], v243 offset:192
    ds_read_b64_tr_b16 v[96:97], v242 offset:1536
    ds_read_b64_tr_b16 v[98:99], v242 offset:1728
    ds_read_b64_tr_b16 v[100:101], v243 offset:1536
    ds_read_b64_tr_b16 v[102:103], v243 offset:1728
    ds_read_b64_tr_b16 v[104:105], v242 offset:3072
    ds_read_b64_tr_b16 v[106:107], v242 offset:3264
    ds_read_b64_tr_b16 v[108:109], v243 offset:3072
    ds_read_b64_tr_b16 v[110:111], v243 offset:3264
    ds_read_b64_tr_b16 v[112:113], v242 offset:4608
    ds_read_b64_tr_b16 v[114:115], v242 offset:4800
    s_waitcnt lgkmcnt(10)
    v_mfma_f32_16x16x32_bf16 v[160:163], v[16:19], v[88:91], 0
    ds_read_b64_tr_b16 v[116:117], v243 offset:4608
    ds_read_b64_tr_b16 v[118:119], v243 offset:4800
    v_mfma_f32_16x16x32_bf16 v[164:167], v[16:19], v[92:95], 0
    ds_read_b64_tr_b16 v[88:89], v242 offset:6144
    ds_read_b64_tr_b16 v[90:91], v242 offset:6336
    s_waitcnt lgkmcnt(10)
    v_mfma_f32_16x16x32_bf16 v[160:163], v[20:23], v[96:99], v[160:163]
    ds_read_b64_tr_b16 v[92:93], v243 offset:6144
    ds_read_b64_tr_b16 v[94:95], v243 offset:6336
    v_mfma_f32_16x16x32_bf16 v[164:167], v[20:23], v[100:103], v[164:167]
    ds_read_b64_tr_b16 v[96:97], v242 offset:7680
    ds_read_b64_tr_b16 v[98:99], v242 offset:7872
    s_waitcnt lgkmcnt(10)
    v_mfma_f32_16x16x32_bf16 v[160:163], v[24:27], v[104:107], v[160:163]
    ds_read_b64_tr_b16 v[100:101], v243 offset:7680
    ds_read_b64_tr_b16 v[102:103], v243 offset:7872
    v_mfma_f32_16x16x32_bf16 v[164:167], v[24:27], v[108:111], v[164:167]
    ds_read_b64_tr_b16 v[104:105], v242 offset:9216
    ds_read_b64_tr_b16 v[106:107], v242 offset:9408
    s_waitcnt lgkmcnt(10)
    v_mfma_f32_16x16x32_bf16 v[160:163], v[28:31], v[112:115], v[160:163]
    ds_read_b64_tr_b16 v[108:109], v243 offset:9216
    ds_read_b64_tr_b16 v[110:111], v243 offset:9408
    v_mfma_f32_16x16x32_bf16 v[164:167], v[28:31], v[116:119], v[164:167]
    ds_read_b64_tr_b16 v[112:113], v242 offset:10752
    ds_read_b64_tr_b16 v[114:115], v242 offset:10944
    s_waitcnt lgkmcnt(10)
    v_mfma_f32_16x16x32_bf16 v[160:163], v[32:35], v[88:91], v[160:163]
    ds_read_b64_tr_b16 v[116:117], v243 offset:10752
    ds_read_b64_tr_b16 v[118:119], v243 offset:10944
    v_mfma_f32_16x16x32_bf16 v[164:167], v[32:35], v[92:95], v[164:167]
    ds_read_b64_tr_b16 v[88:89], v242 offset:12288
    ds_read_b64_tr_b16 v[90:91], v242 offset:12480
    s_waitcnt lgkmcnt(10)
    v_mfma_f32_16x16x32_bf16 v[160:163], v[36:39], v[96:99], v[160:163]
    ds_read_b64_tr_b16 v[92:93], v243 offset:12288
    ds_read_b64_tr_b16 v[94:95], v243 offset:12480
    v_mfma_f32_16x16x32_bf16 v[164:167], v[36:39], v[100:103], v[164:167]
    ds_read_b64_tr_b16 v[96:97], v242 offset:13824
    ds_read_b64_tr_b16 v[98:99], v242 offset:14016
    s_waitcnt lgkmcnt(10)
    v_mfma_f32_16x16x32_bf16 v[160:163], v[40:43], v[104:107], v[160:163]
    ds_read_b64_tr_b16 v[100:101], v243 offset:13824
    ds_read_b64_tr_b16 v[102:103], v243 offset:14016
    v_mfma_f32_16x16x32_bf16 v[164:167], v[40:43], v[108:111], v[164:167]
    ds_read_b64_tr_b16 v[104:105], v242 offset:15360
    ds_read_b64_tr_b16 v[106:107], v242 offset:15552
    s_waitcnt lgkmcnt(10)
    v_mfma_f32_16x16x32_bf16 v[160:163], v[44:47], v[112:115], v[160:163]
    ds_read_b64_tr_b16 v[108:109], v243 offset:15360
    ds_read_b64_tr_b16 v[110:111], v243 offset:15552
    v_mfma_f32_16x16x32_bf16 v[164:167], v[44:47], v[116:119], v[164:167]
    ds_read_b64_tr_b16 v[112:113], v242 offset:16896
    ds_read_b64_tr_b16 v[114:115], v242 offset:17088
    s_waitcnt lgkmcnt(10)
    v_mfma_f32_16x16x32_bf16 v[160:163], v[48:51], v[88:91], v[160:163]
    ds_read_b64_tr_b16 v[116:117], v243 offset:16896
    ds_read_b64_tr_b16 v[118:119], v243 offset:17088
    v_mfma_f32_16x16x32_bf16 v[164:167], v[48:51], v[92:95], v[164:167]
    ds_read_b64_tr_b16 v[88:89], v242 offset:18432
    ds_read_b64_tr_b16 v[90:91], v242 offset:18624
    s_waitcnt lgkmcnt(10)
    v_mfma_f32_16x16x32_bf16 v[160:163], v[52:55], v[96:99], v[160:163]
    ds_read_b64_tr_b16 v[92:93], v243 offset:18432
    ds_read_b64_tr_b16 v[94:95], v243 offset:18624
    v_mfma_f32_16x16x32_bf16 v[164:167], v[52:55], v[100:103], v[164:167]
    ds_read_b64_tr_b16 v[96:97], v242 offset:19968
    ds_read_b64_tr_b16 v[98:99], v242 offset:20160
    s_waitcnt lgkmcnt(10)
    v_mfma_f32_16x16x32_bf16 v[160:163], v[56:59], v[104:107], v[160:163]
    ds_read_b64_tr_b16 v[100:101], v243 offset:19968
    ds_read_b64_tr_b16 v[102:103], v243 offset:20160
    v_mfma_f32_16x16x32_bf16 v[164:167], v[56:59], v[108:111], v[164:167]
    ds_read_b64_tr_b16 v[104:105], v242 offset:21504
    ds_read_b64_tr_b16 v[106:107], v242 offset:21696
    s_waitcnt lgkmcnt(10)
    v_mfma_f32_16x16x32_bf16 v[160:163], v[60:63], v[112:115], v[160:163]
    ds_read_b64_tr_b16 v[108:109], v243 offset:21504
    ds_read_b64_tr_b16 v[110:111], v243 offset:21696
    v_mfma_f32_16x16x32_bf16 v[164:167], v[60:63], v[116:119], v[164:167]
    ds_read_b64_tr_b16 v[112:113], v242 offset:23040
    ds_read_b64_tr_b16 v[114:115], v242 offset:23232
    s_waitcnt lgkmcnt(10)
    v_mfma_f32_16x16x32_bf16 v[160:163], v[64:67], v[88:91], v[160:163]
    ds_read_b64_tr_b16 v[116:117], v243 offset:23040
    ds_read_b64_tr_b16 v[118:119], v243 offset:23232
    v_mfma_f32_16x16x32_bf16 v[164:167], v[64:67], v[92:95], v[164:167]
    ds_read_b64_tr_b16 v[88:89], v242 offset:24576
    ds_read_b64_tr_b16 v[90:91], v242 offset:24768
    s_waitcnt lgkmcnt(10)
    v_mfma_f32_16x16x32_bf16 v[160:163], v[68:71], v[96:99], v[160:163]
    ds_read_b64_tr_b16 v[92:93], v243 offset:24576
    ds_read_b64_tr_b16 v[94:95], v243 offset:24768
    v_mfma_f32_16x16x32_bf16 v[164:167], v[68:71], v[100:103], v[164:167]
    ds_read_b64_tr_b16 v[96:97], v242 offset:26112
    ds_read_b64_tr_b16 v[98:99], v242 offset:26304
    s_waitcnt lgkmcnt(10)
    v_mfma_f32_16x16x32_bf16 v[160:163], v[72:75], v[104:107], v[160:163]
    ds_read_b64_tr_b16 v[100:101], v243 offset:26112
    ds_read_b64_tr_b16 v[102:103], v243 offset:26304
    v_mfma_f32_16x16x32_bf16 v[164:167], v[72:75], v[108:111], v[164:167]
    s_waitcnt lgkmcnt(8)
    v_mfma_f32_16x16x32_bf16 v[160:163], v[76:79], v[112:115], v[160:163]
    v_mfma_f32_16x16x32_bf16 v[164:167], v[76:79], v[116:119], v[164:167]
    s_waitcnt lgkmcnt(4)
    v_mfma_f32_16x16x32_bf16 v[160:163], v[80:83], v[88:91], v[160:163]
    v_mfma_f32_16x16x32_bf16 v[164:167], v[80:83], v[92:95], v[164:167]
    s_waitcnt lgkmcnt(0)
    v_mfma_f32_16x16x32_bf16 v[160:163], v[84:87], v[96:99], v[160:163]
    v_mfma_f32_16x16x32_bf16 v[164:167], v[84:87], v[100:103], v[164:167]
    s_mov_b32 m0, 163588
    s_mov_b64 exec, 1
    global_load_lds_dword v254, s[82:83]
    s_mov_b64 exec, -1
    v_add_u32 v180, s62, v180
    v_add_u32 v181, s62, v181
    v_add_u32 v182, s62, v182
    v_add_u32 v183, s62, v183
    v_add_u32 v184, s62, v184
    v_add_u32 v185, s62, v185
    v_add_u32 v186, s62, v186
    v_add_u32 v187, s62, v187
    v_add_u32 v188, s62, v188
    v_add_u32 v189, s62, v189
    v_add_u32 v190, s62, v190
    v_add_u32 v191, s62, v191
    v_add_u32 v192, s62, v192
    v_add_u32 v193, s62, v193
    v_add_u32 v194, s62, v194
    v_add_u32 v195, s62, v195
    v_add_u32 v196, s62, v196
    v_add_u32 v197, s62, v197
    v_cvt_pk_bf16_f32 v8, v160, v161
    v_cvt_pk_bf16_f32 v9, v162, v163
    v_cvt_pk_bf16_f32 v10, v164, v165
    v_cvt_pk_bf16_f32 v11, v166, v167
    global_store_dwordx2 v236, v[8:9], s[60:61]
    v_cndmask_b32 v10, v10, v237, vcc
    v_cndmask_b32 v11, v11, v237, vcc
    s_mov_b32 exec_lo, 0x000c000c
    s_mov_b32 exec_hi, 0x003c003c
    global_store_dwordx2 v236, v[10:11], s[60:61] offset:224
    global_store_dwordx2 v236, v[10:11], s[48:49] offset:224 sc1
    s_mov_b64 exec, -1
    global_store_dwordx2 v236, v[8:9], s[48:49] sc1
L_pub:
    s_waitcnt vmcnt(2)
    s_mov_b64 exec, 1
    global_store_dword v240, v241, s[48:49]
    s_mov_b64 exec, -1
Lspin_10:
    ds_read_b32 v8, v253 offset:36
    s_waitcnt lgkmcnt(0)
    v_cmp_gt_u32 vcc, 1, v8
    s_cbranch_vccnz Lspin_10_s
    s_branch L_xb
L_np:
Lspin_11:
    ds_read_b32 v8, v253 offset:36
    s_waitcnt lgkmcnt(0)
    v_cmp_gt_u32 vcc, 1, v8
    s_cbranch_vccnz Lspin_11_s
    ds_read_b128 v[16:19], v180
    ds_read_b128 v[20:23], v181
    ds_read_b128 v[24:27], v182
    ds_read_b128 v[28:31], v183
    ds_read_b128 v[32:35], v184
    ds_read_b128 v[36:39], v185
    ds_read_b128 v[40:43], v186
    ds_read_b128 v[44:47], v187
    ds_read_b128 v[48:51], v188
    ds_read_b128 v[52:55], v189
    ds_read_b128 v[56:59], v190
    ds_read_b128 v[60:63], v191
    ds_read_b128 v[64:67], v192
    ds_read_b128 v[68:71], v193
    ds_read_b128 v[72:75], v194
    ds_read_b128 v[76:79], v195
    ds_read_b128 v[80:83], v196
    ds_read_b128 v[84:87], v197
    v_add_u32 v180, s62, v180
    v_add_u32 v181, s62, v181
    v_add_u32 v182, s62, v182
    v_add_u32 v183, s62, v183
    v_add_u32 v184, s62, v184
    v_add_u32 v185, s62, v185
    v_add_u32 v186, s62, v186
    v_add_u32 v187, s62, v187
    v_add_u32 v188, s62, v188
    v_add_u32 v189, s62, v189
    v_add_u32 v190, s62, v190
    v_add_u32 v191, s62, v191
    v_add_u32 v192, s62, v192
    v_add_u32 v193, s62, v193
    v_add_u32 v194, s62, v194
    v_add_u32 v195, s62, v195
    v_add_u32 v196, s62, v196
    v_add_u32 v197, s62, v197
Lspin_12:
    ds_read_b32 v8, v253 offset:4
    s_waitcnt lgkmcnt(0)
    v_cmp_gt_u32 vcc, 1, v8
    s_cbranch_vccnz Lspin_12_s
L_xb:
    ds_read_b128 v[88:91], v180
    ds_read_b128 v[92:95], v181
    ds_read_b128 v[96:99], v182
    ds_read_b128 v[100:103], v183
    ds_read_b128 v[104:107], v184
    ds_read_b128 v[108:111], v185
    ds_read_b128 v[112:115], v186
    ds_read_b128 v[116:119], v187
    ds_read_b128 v[120:123], v188
    ds_read_b128 v[124:127], v189
    ds_read_b128 v[128:131], v190
    ds_read_b128 v[132:135], v191
    ds_read_b128 v[136:139], v192
    ds_read_b128 v[140:143], v193
    ds_read_b128 v[144:147], v194
    ds_read_b128 v[148:151], v195
    ds_read_b128 v[152:155], v196
    ds_read_b128 v[156:159], v197
    v_mov_b32 v2, 1
    s_mov_b64 exec, 1
    ds_add_u32 v253, v2 offset:0
    s_mov_b64 exec, -1
    s_setprio 2
    ds_read_b32 v4, v253 offset:24
    s_waitcnt lgkmcnt(0)
    v_readfirstlane_b32 s7, v4
Lspin_13:
    ds_read_b32 v2, v253 offset:148
    s_waitcnt lgkmcnt(0)
    v_cmp_gt_u32 vcc, 1, v2
    s_cbranch_vccnz Lspin_13_s
    s_cmp_lg_u32 s80, s3
    s_cbranch_scc1 L_nogf
    s_waitcnt vmcnt(0)
    s_mov_b64 exec, 1
    global_store_dword v238, v239, s[48:49] sc1
    s_mov_b64 exec, -1
L_nogf:
    ds_read_b64_tr_b16 v[180:181], v214 offset:32768
    ds_read_b64_tr_b16 v[182:183], v214 offset:33280
    ds_read_b64_tr_b16 v[184:185], v215 offset:32768
    ds_read_b64_tr_b16 v[186:187], v215 offset:33280
    ds_read_b64_tr_b16 v[188:189], v216 offset:0
    ds_read_b64_tr_b16 v[190:191], v216 offset:64
    ds_read_b64_tr_b16 v[192:193], v214 offset:28672
    ds_read_b64_tr_b16 v[194:195], v214 offset:29184
    ds_read_b64_tr_b16 v[196:197], v215 offset:28672
    ds_read_b64_tr_b16 v[198:199], v215 offset:29184
    ds_read_b64_tr_b16 v[200:201], v216 offset:512
    ds_read_b64_tr_b16 v[202:203], v216 offset:576
    s_waitcnt lgkmcnt(6)
    v_mfma_f32_16x16x32_bf16 v[160:163], v[180:183], v[16:19], 0
    ds_read_b64_tr_b16 v[204:205], v214 offset:24576
    ds_read_b64_tr_b16 v[206:207], v214 offset:25088
    v_mfma_f32_16x16x32_bf16 v[168:171], v[180:183], v[88:91], 0
    v_mfma_f32_16x16x32_bf16 v[164:167], v[184:187], v[16:19], 0
    ds_read_b64_tr_b16 v[208:209], v215 offset:24576
    ds_read_b64_tr_b16 v[210:211], v215 offset:25088
    v_mfma_f32_16x16x32_bf16 v[172:175], v[184:187], v[88:91], 0
    ds_read_b64_tr_b16 v[180:181], v216 offset:1024
    ds_read_b64_tr_b16 v[182:183], v216 offset:1088
    v_mfma_f32_16x16x32_bf16 v[176:179], v[188:191], v[16:19], 0
    s_waitcnt lgkmcnt(6)
    v_mfma_f32_16x16x32_bf16 v[160:163], v[192:195], v[20:23], v[160:163]
    ds_read_b64_tr_b16 v[184:185], v214 offset:20480
    ds_read_b64_tr_b16 v[186:187], v214 offset:20992
    v_mfma_f32_16x16x32_bf16 v[168:171], v[192:195], v[92:95], v[168:171]
    v_mfma_f32_16x16x32_bf16 v[164:167], v[196:199], v[20:23], v[164:167]
    ds_read_b64_tr_b16 v[188:189], v215 offset:20480
    ds_read_b64_tr_b16 v[190:191], v215 offset:20992
    v_mfma_f32_16x16x32_bf16 v[172:175], v[196:199], v[92:95], v[172:175]
    ds_read_b64_tr_b16 v[192:193], v216 offset:1536
    ds_read_b64_tr_b16 v[194:195], v216 offset:1600
    v_mfma_f32_16x16x32_bf16 v[176:179], v[200:203], v[20:23], v[176:179]
    s_waitcnt lgkmcnt(6)
    v_mfma_f32_16x16x32_bf16 v[160:163], v[204:207], v[24:27], v[160:163]
Lspin_14:
    ds_read_b32 v2, v253 offset:156
    s_waitcnt lgkmcnt(0)
    v_cmp_gt_u32 vcc, 1, v2
    s_cbranch_vccnz Lspin_14_s
    ds_read_b64_tr_b16 v[196:197], v214 offset:16384
    ds_read_b64_tr_b16 v[198:199], v214 offset:16896
    v_mfma_f32_16x16x32_bf16 v[168:171], v[204:207], v[96:99], v[168:171]
    v_mfma_f32_16x16x32_bf16 v[164:167], v[208:211], v[24:27], v[164:167]
    ds_read_b64_tr_b16 v[200:201], v215 offset:16384
    ds_read_b64_tr_b16 v[202:203], v215 offset:16896
    v_mfma_f32_16x16x32_bf16 v[172:175], v[208:211], v[96:99], v[172:175]
    ds_read_b64_tr_b16 v[204:205], v216 offset:2048
    ds_read_b64_tr_b16 v[206:207], v216 offset:2112
    v_mfma_f32_16x16x32_bf16 v[176:179], v[180:183], v[24:27], v[176:179]
    s_waitcnt lgkmcnt(6)
    v_mfma_f32_16x16x32_bf16 v[160:163], v[184:187], v[28:31], v[160:163]
    ds_read_b64_tr_b16 v[208:209], v214 offset:12288
    ds_read_b64_tr_b16 v[210:211], v214 offset:12800
    v_mfma_f32_16x16x32_bf16 v[168:171], v[184:187], v[100:103], v[168:171]
    v_mfma_f32_16x16x32_bf16 v[164:167], v[188:191], v[28:31], v[164:167]
    ds_read_b64_tr_b16 v[180:181], v215 offset:12288
    ds_read_b64_tr_b16 v[182:183], v215 offset:12800
    v_mfma_f32_16x16x32_bf16 v[172:175], v[188:191], v[100:103], v[172:175]
    ds_read_b64_tr_b16 v[184:185], v216 offset:2560
    ds_read_b64_tr_b16 v[186:187], v216 offset:2624
    v_mfma_f32_16x16x32_bf16 v[176:179], v[192:195], v[28:31], v[176:179]
    s_waitcnt lgkmcnt(6)
    v_mfma_f32_16x16x32_bf16 v[160:163], v[196:199], v[32:35], v[160:163]
    ds_read_b64_tr_b16 v[188:189], v214 offset:8192
    ds_read_b64_tr_b16 v[190:191], v214 offset:8704
    v_mfma_f32_16x16x32_bf16 v[168:171], v[196:199], v[104:107], v[168:171]
    v_mfma_f32_16x16x32_bf16 v[164:167], v[200:203], v[32:35], v[164:167]
    ds_read_b64_tr_b16 v[192:193], v215 offset:8192
    ds_read_b64_tr_b16 v[194:195], v215 offset:8704
    v_mfma_f32_16x16x32_bf16 v[172:175], v[200:203], v[104:107], v[172:175]
    ds_read_b64_tr_b16 v[196:197], v216 offset:3072
    ds_read_b64_tr_b16 v[198:199], v216 offset:3136
    v_mfma_f32_16x16x32_bf16 v[176:179], v[204:207], v[32:35], v[176:179]
    s_waitcnt lgkmcnt(6)
    v_mfma_f32_16x16x32_bf16 v[160:163], v[208:211], v[36:39], v[160:163]
    ds_read_b64_tr_b16 v[200:201], v214 offset:4096
    ds_read_b64_tr_b16 v[202:203], v214 offset:4608
    v_mfma_f32_16x16x32_bf16 v[168:171], v[208:211], v[108:111], v[168:171]
    v_mfma_f32_16x16x32_bf16 v[164:167], v[180:183], v[36:39], v[164:167]
    ds_read_b64_tr_b16 v[204:205], v215 offset:4096
    ds_read_b64_tr_b16 v[206:207], v215 offset:4608
    v_mfma_f32_16x16x32_bf16 v[172:175], v[180:183], v[108:111], v[172:175]
    ds_read_b64_tr_b16 v[208:209], v216 offset:3584
    ds_read_b64_tr_b16 v[210:211], v216 offset:3648
    v_mfma_f32_16x16x32_bf16 v[176:179], v[184:187], v[36:39], v[176:179]
    s_waitcnt lgkmcnt(6)
    v_mfma_f32_16x16x32_bf16 v[160:163], v[188:191], v[40:43], v[160:163]
Lspin_15:
    ds_read_b32 v2, v253 offset:164
    s_waitcnt lgkmcnt(0)
    v_cmp_gt_u32 vcc, 1, v2
    s_cbranch_vccnz Lspin_15_s
    ds_read_b64_tr_b16 v[180:181], v214 offset:0
    ds_read_b64_tr_b16 v[182:183], v214 offset:512
    v_mfma_f32_16x16x32_bf16 v[168:171], v[188:191], v[112:115], v[168:171]
    v_mfma_f32_16x16x32_bf16 v[164:167], v[192:195], v[40:43], v[164:167]
    ds_read_b64_tr_b16 v[184:185], v215 offset:0
    ds_read_b64_tr_b16 v[186:187], v215 offset:512
    v_mfma_f32_16x16x32_bf16 v[172:175], v[192:195], v[112:115], v[172:175]
    ds_read_b64_tr_b16 v[188:189], v216 offset:4096
    ds_read_b64_tr_b16 v[190:191], v216 offset:4160
    v_mfma_f32_16x16x32_bf16 v[176:179], v[196:199], v[40:43], v[176:179]
    s_waitcnt lgkmcnt(6)
    v_mfma_f32_16x16x32_bf16 v[160:163], v[200:203], v[44:47], v[160:163]
    ds_read_b64_tr_b16 v[192:193], v212 offset:32768
    ds_read_b64_tr_b16 v[194:195], v212 offset:33280
    v_mfma_f32_16x16x32_bf16 v[168:171], v[200:203], v[116:119], v[168:171]
    v_mfma_f32_16x16x32_bf16 v[164:167], v[204:207], v[44:47], v[164:167]
    ds_read_b64_tr_b16 v[196:197], v213 offset:32768
    ds_read_b64_tr_b16 v[198:199], v213 offset:33280
    v_mfma_f32_16x16x32_bf16 v[172:175], v[204:207], v[116:119], v[172:175]
    ds_read_b64_tr_b16 v[200:201], v216 offset:4608
    ds_read_b64_tr_b16 v[202:203], v216 offset:4672
    v_mfma_f32_16x16x32_bf16 v[176:179], v[208:211], v[44:47], v[176:179]
    s_waitcnt lgkmcnt(6)
    v_mfma_f32_16x16x32_bf16 v[160:163], v[180:183], v[48:51], v[160:163]
    ds_read_b64_tr_b16 v[204:205], v212 offset:28672
    ds_read_b64_tr_b16 v[206:207], v212 offset:29184
    v_mfma_f32_16x16x32_bf16 v[168:171], v[180:183], v[120:123], v[168:171]
    v_mfma_f32_16x16x32_bf16 v[164:167], v[184:187], v[48:51], v[164:167]
    ds_read_b64_tr_b16 v[208:209], v213 offset:28672
    ds_read_b64_tr_b16 v[210:211], v213 offset:29184
    v_mfma_f32_16x16x32_bf16 v[172:175], v[184:187], v[120:123], v[172:175]
    ds_read_b64_tr_b16 v[180:181], v216 offset:5120
    ds_read_b64_tr_b16 v[182:183], v216 offset:5184
    v_mfma_f32_16x16x32_bf16 v[176:179], v[188:191], v[48:51], v[176:179]
    s_waitcnt lgkmcnt(6)
    v_mfma_f32_16x16x32_bf16 v[160:163], v[192:195], v[52:55], v[160:163]
    ds_read_b64_tr_b16 v[184:185], v212 offset:24576
    ds_read_b64_tr_b16 v[186:187], v212 offset:25088
    v_mfma_f32_16x16x32_bf16 v[168:171], v[192:195], v[124:127], v[168:171]
    v_mfma_f32_16x16x32_bf16 v[164:167], v[196:199], v[52:55], v[164:167]
    ds_read_b64_tr_b16 v[188:189], v213 offset:24576
    ds_read_b64_tr_b16 v[190:191], v213 offset:25088
    v_mfma_f32_16x16x32_bf16 v[172:175], v[196:199], v[124:127], v[172:175]
    ds_read_b64_tr_b16 v[192:193], v216 offset:5632
    ds_read_b64_tr_b16 v[194:195], v216 offset:5696
    v_mfma_f32_16x16x32_bf16 v[176:179], v[200:203], v[52:55], v[176:179]
    s_waitcnt lgkmcnt(6)
    v_mfma_f32_16x16x32_bf16 v[160:163], v[204:207], v[56:59], v[160:163]
Lspin_16:
    ds_read_b32 v2, v253 offset:168
    s_waitcnt lgkmcnt(0)
    v_cmp_gt_u32 vcc, 1, v2
    s_cbranch_vccnz Lspin_16_s
    ds_read_b64_tr_b16 v[196:197], v212 offset:20480
    ds_read_b64_tr_b16 v[198:199], v212 offset:20992
    v_mfma_f32_16x16x32_bf16 v[168:171], v[204:207], v[128:131], v[168:171]
    v_mfma_f32_16x16x32_bf16 v[164:167], v[208:211], v[56:59], v[164:167]
    ds_read_b64_tr_b16 v[200:201], v213 offset:20480
    ds_read_b64_tr_b16 v[202:203], v213 offset:20992
    v_mfma_f32_16x16x32_bf16 v[172:175], v[208:211], v[128:131], v[172:175]
    ds_read_b64_tr_b16 v[204:205], v216 offset:6144
    ds_read_b64_tr_b16 v[206:207], v216 offset:6208
    v_mfma_f32_16x16x32_bf16 v[176:179], v[180:183], v[56:59], v[176:179]
    s_waitcnt lgkmcnt(6)
    v_mfma_f32_16x16x32_bf16 v[160:163], v[184:187], v[60:63], v[160:163]
    ds_read_b64_tr_b16 v[208:209], v212 offset:16384
    ds_read_b64_tr_b16 v[210:211], v212 offset:16896
    v_mfma_f32_16x16x32_bf16 v[168:171], v[184:187], v[132:135], v[168:171]
    v_mfma_f32_16x16x32_bf16 v[164:167], v[188:191], v[60:63], v[164:167]
    ds_read_b64_tr_b16 v[180:181], v213 offset:16384
    ds_read_b64_tr_b16 v[182:183], v213 offset:16896
    v_mfma_f32_16x16x32_bf16 v[172:175], v[188:191], v[132:135], v[172:175]
    ds_read_b64_tr_b16 v[184:185], v216 offset:6656
    ds_read_b64_tr_b16 v[186:187], v216 offset:6720
    v_mfma_f32_16x16x32_bf16 v[176:179], v[192:195], v[60:63], v[176:179]
    s_waitcnt lgkmcnt(6)
    v_mfma_f32_16x16x32_bf16 v[160:163], v[196:199], v[64:67], v[160:163]
Lspin_17:
    ds_read_b32 v2, v253 offset:172
    s_waitcnt lgkmcnt(0)
    v_cmp_gt_u32 vcc, 1, v2
    s_cbranch_vccnz Lspin_17_s
    ds_read_b64_tr_b16 v[188:189], v212 offset:12288
    ds_read_b64_tr_b16 v[190:191], v212 offset:12800
    v_mfma_f32_16x16x32_bf16 v[168:171], v[196:199], v[136:139], v[168:171]
    v_mfma_f32_16x16x32_bf16 v[164:167], v[200:203], v[64:67], v[164:167]
    ds_read_b64_tr_b16 v[192:193], v213 offset:12288
    ds_read_b64_tr_b16 v[194:195], v213 offset:12800
    v_mfma_f32_16x16x32_bf16 v[172:175], v[200:203], v[136:139], v[172:175]
    ds_read_b64_tr_b16 v[196:197], v216 offset:7168
    ds_read_b64_tr_b16 v[198:199], v216 offset:7232
    v_mfma_f32_16x16x32_bf16 v[176:179], v[204:207], v[64:67], v[176:179]
    s_waitcnt lgkmcnt(6)
    v_mfma_f32_16x16x32_bf16 v[160:163], v[208:211], v[68:71], v[160:163]
    ds_read_b64_tr_b16 v[200:201], v212 offset:8192
    ds_read_b64_tr_b16 v[202:203], v212 offset:8704
    v_mfma_f32_16x16x32_bf16 v[168:171], v[208:211], v[140:143], v[168:171]
    v_mfma_f32_16x16x32_bf16 v[164:167], v[180:183], v[68:71], v[164:167]
    ds_read_b64_tr_b16 v[204:205], v213 offset:8192
    ds_read_b64_tr_b16 v[206:207], v213 offset:8704
    v_mfma_f32_16x16x32_bf16 v[172:175], v[180:183], v[140:143], v[172:175]
    ds_read_b64_tr_b16 v[208:209], v216 offset:7680
    ds_read_b64_tr_b16 v[210:211], v216 offset:7744
    v_mfma_f32_16x16x32_bf16 v[176:179], v[184:187], v[68:71], v[176:179]
    s_waitcnt lgkmcnt(6)
    v_mfma_f32_16x16x32_bf16 v[160:163], v[188:191], v[72:75], v[160:163]
Lspin_18:
    ds_read_b32 v2, v253 offset:176
    s_waitcnt lgkmcnt(0)
    v_cmp_gt_u32 vcc, 1, v2
    s_cbranch_vccnz Lspin_18_s
    ds_read_b64_tr_b16 v[180:181], v212 offset:4096
    ds_read_b64_tr_b16 v[182:183], v212 offset:4608
    v_mfma_f32_16x16x32_bf16 v[168:171], v[188:191], v[144:147], v[168:171]
    v_mfma_f32_16x16x32_bf16 v[164:167], v[192:195], v[72:75], v[164:167]
    ds_read_b64_tr_b16 v[184:185], v213 offset:4096
    ds_read_b64_tr_b16 v[186:187], v213 offset:4608
    v_mfma_f32_16x16x32_bf16 v[172:175], v[192:195], v[144:147], v[172:175]
    ds_read_b64_tr_b16 v[188:189], v216 offset:8192
    ds_read_b64_tr_b16 v[190:191], v216 offset:8256
    v_mfma_f32_16x16x32_bf16 v[176:179], v[196:199], v[72:75], v[176:179]
    s_waitcnt lgkmcnt(6)
    v_mfma_f32_16x16x32_bf16 v[160:163], v[200:203], v[76:79], v[160:163]
    ds_read_b64_tr_b16 v[192:193], v212 offset:0
    ds_read_b64_tr_b16 v[194:195], v212 offset:512
    v_mfma_f32_16x16x32_bf16 v[168:171], v[200:203], v[148:151], v[168:171]
    v_mfma_f32_16x16x32_bf16 v[164:167], v[204:207], v[76:79], v[164:167]
    ds_read_b64_tr_b16 v[196:197], v213 offset:0
    ds_read_b64_tr_b16 v[198:199], v213 offset:512
    v_mfma_f32_16x16x32_bf16 v[172:175], v[204:207], v[148:151], v[172:175]
    ds_read_b64_tr_b16 v[200:201], v216 offset:8704
    ds_read_b64_tr_b16 v[202:203], v216 offset:8768
    v_mfma_f32_16x16x32_bf16 v[176:179], v[208:211], v[76:79], v[176:179]
    s_waitcnt lgkmcnt(6)
    v_mfma_f32_16x16x32_bf16 v[160:163], v[180:183], v[80:83], v[160:163]
    v_mfma_f32_16x16x32_bf16 v[168:171], v[180:183], v[152:155], v[168:171]
    v_mfma_f32_16x16x32_bf16 v[164:167], v[184:187], v[80:83], v[164:167]
    v_mfma_f32_16x16x32_bf16 v[172:175], v[184:187], v[152:155], v[172:175]
    v_mfma_f32_16x16x32_bf16 v[176:179], v[188:191], v[80:83], v[176:179]
    s_waitcnt lgkmcnt(0)
    v_mfma_f32_16x16x32_bf16 v[160:163], v[192:195], v[84:87], v[160:163]
    v_mfma_f32_16x16x32_bf16 v[168:171], v[192:195], v[156:159], v[168:171]
    v_mfma_f32_16x16x32_bf16 v[164:167], v[196:199], v[84:87], v[164:167]
    v_mfma_f32_16x16x32_bf16 v[172:175], v[196:199], v[156:159], v[172:175]
    v_mfma_f32_16x16x32_bf16 v[176:179], v[200:203], v[84:87], v[176:179]
    s_mul_i32 s54, s58, 2304
    s_sub_u32 s55, 2304, s54
    v_add_u32 v2, s54, v227
    v_add_u32 v3, s55, v227
    v_mfma_f32_32x32x4_2b_bf16 v[80:111], v[246:247], v[246:247], 0
    v_cvt_pk_bf16_f32 v160, v160, v161
    v_cvt_pk_bf16_f32 v161, v162, v163
    ds_write_b64 v2, v[160:161] offset:0
    v_cvt_pk_bf16_f32 v168, v168, v169
    v_cvt_pk_bf16_f32 v169, v170, v171
    ds_write_b64 v3, v[168:169] offset:0
    v_cvt_pk_bf16_f32 v164, v164, v165
    v_cvt_pk_bf16_f32 v165, v166, v167
    ds_write_b64 v2, v[164:165] offset:32
    v_cvt_pk_bf16_f32 v172, v172, v173
    v_cvt_pk_bf16_f32 v173, v174, v175
    ds_write_b64 v3, v[172:173] offset:32
    v_cvt_pk_bf16_f32 v176, v176, v177
    v_cvt_pk_bf16_f32 v177, v178, v179
    s_mov_b32 exec_hi, 0
    ds_write_b64 v228, v[176:177] offset:128
    s_mov_b64 exec, 1
    v_mov_b32 v4, 1
    ds_add_u32 v229, v4 offset:40
    s_mov_b64 exec, -1
    v_mov_b32 v72, 0
    v_mov_b32 v73, 0
    v_mov_b32 v74, 0
    v_mov_b32 v75, 0
    v_mov_b32 v76, 0
    v_mov_b32 v77, 0
    v_mov_b32 v78, 0
    v_mov_b32 v79, 0
    v_mov_b32 v144, 0
    v_mov_b32 v145, 0
    v_mov_b32 v146, 0
    v_mov_b32 v147, 0
    v_mov_b32 v121, 0
    v_mov_b32 v122, 0
Lspin_19:
    ds_read_b32 v8, v229 offset:40
    s_waitcnt lgkmcnt(0)
    v_cmp_gt_u32 vcc, 2, v8
    s_cbranch_vccnz Lspin_19
    ds_read_b32 v120, v226 offset:32
    ds_read2_b32 v[112:113], v225 offset0:0 offset1:1
    ds_read2_b32 v[114:115], v225 offset0:2 offset1:3
    ds_read2_b32 v[116:117], v225 offset0:9 offset1:10
    ds_read2_b32 v[118:119], v225 offset0:11 offset1:12
    ds_read_b32 v123, v226 offset:32
    s_mov_b64 exec, 1
    ds_add_u32 v253, v4 offset:8
    s_mov_b64 exec, -1
Lspin_20:
    ds_read_b32 v8, v253 offset:96
    s_waitcnt lgkmcnt(0)
    v_cmp_gt_u32 vcc, 1, v8
    s_cbranch_vccnz Lspin_20
    ds_read_b128 v[148:151], v217 offset:17920
    ds_read_b128 v[124:127], v217
    ds_read_b128 v[128:131], v217 offset:2240
    ds_read_b128 v[132:135], v218
    ds_read_b128 v[140:143], v218 offset:608
    ds_read_b32 v8, v253 offset:28
    s_waitcnt lgkmcnt(5)
    v_mfma_f32_32x32x4_2b_bf16 v[16:47], v[148:149], v[120:121], 0 cbsz:1 abid:0
    s_waitcnt lgkmcnt(0)
    v_readfirstlane_b32 s71, v8
    s_setprio 0
    s_nop 14
    v_mfma_f32_32x32x16_bf16 v[16:31], v[124:127], v[112:115], v[16:31]
    v_mfma_f32_32x32x16_bf16 v[32:47], v[124:127], v[116:119], v[32:47]
    s_nop 10
.p2align 3
L_att:
    v_exp_f32 v16, v16
    v_exp_f32 v17, v17
    v_smfmac_f32_32x32x32_bf16 v[96:111], v[144:147], v[72:79], v233
    s_waitcnt lgkmcnt(0)
    v_exp_f32 v18, v18
    v_exp_f32 v19, v19
    v_exp_f32 v20, v20
    v_mfma_f32_32x32x4_2b_bf16 v[48:79], v[148:149], v[120:121], 0 cbsz:1 abid:1
    v_exp_f32 v21, v21
    v_exp_f32 v22, v22
    v_exp_f32 v23, v23
    v_exp_f32 v24, v24
    v_exp_f32 v25, v25
    v_exp_f32 v26, v26
    v_exp_f32 v27, v27
    v_exp_f32 v28, v28
    v_smfmac_f32_32x32x32_bf16 v[80:95], v[132:135], v[16:23], v233
    ds_read_b128 v[124:127], v217 offset:4480
    v_exp_f32 v29, v29
    v_exp_f32 v30, v30
    v_exp_f32 v31, v31
    v_exp_f32 v32, v32
    v_exp_f32 v33, v33
    v_smfmac_f32_32x32x32_bf16 v[80:95], v[140:143], v[24:31], v233
    ds_read_b128 v[136:139], v218 offset:2240
    v_exp_f32 v34, v34
    v_exp_f32 v35, v35
    v_exp_f32 v36, v36
    v_exp_f32 v37, v37
    v_mfma_f32_32x32x16_bf16 v[48:63], v[128:131], v[112:115], v[48:63]
    ds_read_b128 v[144:147], v218 offset:2848
    v_exp_f32 v38, v38
    v_exp_f32 v39, v39
    v_exp_f32 v40, v40
    v_exp_f32 v41, v41
    v_smfmac_f32_32x32x32_bf16 v[96:111], v[132:135], v[32:39], v233
    v_exp_f32 v42, v42
    v_exp_f32 v43, v43
    v_exp_f32 v44, v44
    v_mfma_f32_32x32x16_bf16 v[64:79], v[128:131], v[116:119], v[64:79]
    v_exp_f32 v45, v45
    v_exp_f32 v46, v46
    v_exp_f32 v47, v47
    v_exp_f32 v48, v48
    v_exp_f32 v49, v49
    v_smfmac_f32_32x32x32_bf16 v[96:111], v[140:143], v[40:47], v233
    s_waitcnt lgkmcnt(0)
    v_exp_f32 v50, v50
    v_exp_f32 v51, v51
    v_exp_f32 v52, v52
    v_mfma_f32_32x32x4_2b_bf16 v[16:47], v[148:149], v[122:123], 0 cbsz:1 abid:0
    v_exp_f32 v53, v53
    v_exp_f32 v54, v54
    v_exp_f32 v55, v55
    v_exp_f32 v56, v56
    v_exp_f32 v57, v57
    v_exp_f32 v58, v58
    v_exp_f32 v59, v59
    v_exp_f32 v60, v60
    v_smfmac_f32_32x32x32_bf16 v[80:95], v[136:139], v[48:55], v233
    ds_read_b128 v[128:131], v217 offset:6720
    v_exp_f32 v61, v61
    v_exp_f32 v62, v62
    v_exp_f32 v63, v63
    v_exp_f32 v64, v64
    v_exp_f32 v65, v65
    v_smfmac_f32_32x32x32_bf16 v[80:95], v[144:147], v[56:63], v233
    ds_read_b128 v[132:135], v218 offset:4480
    v_exp_f32 v66, v66
    v_exp_f32 v67, v67
    v_exp_f32 v68, v68
    v_exp_f32 v69, v69
    v_mfma_f32_32x32x16_bf16 v[16:31], v[124:127], v[112:115], v[16:31]
    ds_read_b128 v[140:143], v218 offset:5088
    v_exp_f32 v70, v70
    v_exp_f32 v71, v71
    v_exp_f32 v72, v72
    v_exp_f32 v73, v73
    v_smfmac_f32_32x32x32_bf16 v[96:111], v[136:139], v[64:71], v233
    v_exp_f32 v74, v74
    v_exp_f32 v75, v75
    v_exp_f32 v76, v76
    v_mfma_f32_32x32x16_bf16 v[32:47], v[124:127], v[116:119], v[32:47]
    s_add_u32 s68, s68, 1
    v_exp_f32 v77, v77
    v_exp_f32 v78, v78
    v_exp_f32 v79, v79
    v_exp_f32 v16, v16
    v_exp_f32 v17, v17
    v_smfmac_f32_32x32x32_bf16 v[96:111], v[144:147], v[72:79], v233
    s_waitcnt lgkmcnt(0)
    v_exp_f32 v18, v18
    v_exp_f32 v19, v19
    v_exp_f32 v20, v20
    v_mfma_f32_32x32x4_2b_bf16 v[48:79], v[148:149], v[122:123], 0 cbsz:1 abid:1
    v_exp_f32 v21, v21
    v_exp_f32 v22, v22
    v_exp_f32 v23, v23
    v_exp_f32 v24, v24
    v_exp_f32 v25, v25
    v_exp_f32 v26, v26
    v_exp_f32 v27, v27
    v_exp_f32 v28, v28
    v_smfmac_f32_32x32x32_bf16 v[80:95], v[132:135], v[16:23], v233
    ds_read_b128 v[124:127], v217 offset:8960
    v_exp_f32 v29, v29
    v_exp_f32 v30, v30
    v_exp_f32 v31, v31
    v_exp_f32 v32, v32
    v_exp_f32 v33, v33
    v_smfmac_f32_32x32x32_bf16 v[80:95], v[140:143], v[24:31], v233
    ds_read_b128 v[136:139], v218 offset:6720
    v_exp_f32 v34, v34
    v_exp_f32 v35, v35
    v_exp_f32 v36, v36
    v_exp_f32 v37, v37
    v_mfma_f32_32x32x16_bf16 v[48:63], v[128:131], v[112:115], v[48:63]
    ds_read_b128 v[144:147], v218 offset:7328
    v_exp_f32 v38, v38
    v_exp_f32 v39, v39
    v_exp_f32 v40, v40
    v_exp_f32 v41, v41
    v_smfmac_f32_32x32x32_bf16 v[96:111], v[132:135], v[32:39], v233
    s_and_b32 s70, s69, 15
    v_exp_f32 v42, v42
    v_exp_f32 v43, v43
    v_exp_f32 v44, v44
    v_mfma_f32_32x32x16_bf16 v[64:79], v[128:131], v[116:119], v[64:79]
    s_mul_i32 s70, s70, 18944
    v_exp_f32 v45, v45
    v_exp_f32 v46, v46
    v_exp_f32 v47, v47
    v_exp_f32 v48, v48
    v_exp_f32 v49, v49
    v_smfmac_f32_32x32x32_bf16 v[96:111], v[140:143], v[40:47], v233
    s_waitcnt lgkmcnt(0)
    v_exp_f32 v50, v50
    v_exp_f32 v51, v51
    v_exp_f32 v52, v52
    v_mfma_f32_32x32x4_2b_bf16 v[16:47], v[150:151], v[120:121], 0 cbsz:1 abid:0
    v_exp_f32 v53, v53
    v_exp_f32 v54, v54
    v_exp_f32 v55, v55
    v_exp_f32 v56, v56
    v_exp_f32 v57, v57
    v_exp_f32 v58, v58
    v_exp_f32 v59, v59
    v_exp_f32 v60, v60
    v_smfmac_f32_32x32x32_bf16 v[80:95], v[136:139], v[48:55], v233
    ds_read_b128 v[128:131], v217 offset:11200
    v_exp_f32 v61, v61
    v_exp_f32 v62, v62
    v_exp_f32 v63, v63
    v_exp_f32 v64, v64
    v_exp_f32 v65, v65
    v_smfmac_f32_32x32x32_bf16 v[80:95], v[144:147], v[56:63], v233
    ds_read_b128 v[132:135], v218 offset:8960
    v_exp_f32 v66, v66
    v_exp_f32 v67, v67
    v_exp_f32 v68, v68
    v_exp_f32 v69, v69
    v_mfma_f32_32x32x16_bf16 v[16:31], v[124:127], v[112:115], v[16:31]
    ds_read_b128 v[140:143], v218 offset:9568
    v_exp_f32 v70, v70
    v_exp_f32 v71, v71
    v_exp_f32 v72, v72
    v_exp_f32 v73, v73
    v_smfmac_f32_32x32x32_bf16 v[96:111], v[136:139], v[64:71], v233
    s_add_u32 s70, s70, 49920
    v_exp_f32 v74, v74
    v_exp_f32 v75, v75
    v_exp_f32 v76, v76
    v_mfma_f32_32x32x16_bf16 v[32:47], v[124:127], v[116:119], v[32:47]
    s_lshr_b32 s69, s69, 4
    v_exp_f32 v77, v77
    v_exp_f32 v78, v78
    v_exp_f32 v79, v79
    v_exp_f32 v16, v16
    v_exp_f32 v17, v17
    v_smfmac_f32_32x32x32_bf16 v[96:111], v[144:147], v[72:79], v233
    s_waitcnt lgkmcnt(0)
    v_exp_f32 v18, v18
    v_exp_f32 v19, v19
    v_exp_f32 v20, v20
    v_mfma_f32_32x32x4_2b_bf16 v[48:79], v[150:151], v[120:121], 0 cbsz:1 abid:1
    v_exp_f32 v21, v21
    v_exp_f32 v22, v22
    v_exp_f32 v23, v23
    v_exp_f32 v24, v24
    v_exp_f32 v25, v25
    v_exp_f32 v26, v26
    v_exp_f32 v27, v27
    v_exp_f32 v28, v28
    v_smfmac_f32_32x32x32_bf16 v[80:95], v[132:135], v[16:23], v233
    ds_read_b128 v[124:127], v217 offset:13440
    v_exp_f32 v29, v29
    v_exp_f32 v30, v30
    v_exp_f32 v31, v31
    v_exp_f32 v32, v32
    v_exp_f32 v33, v33
    v_smfmac_f32_32x32x32_bf16 v[80:95], v[140:143], v[24:31], v233
    ds_read_b128 v[136:139], v218 offset:11200
    v_exp_f32 v34, v34
    v_exp_f32 v35, v35
    v_exp_f32 v36, v36
    v_exp_f32 v37, v37
    v_mfma_f32_32x32x16_bf16 v[48:63], v[128:131], v[112:115], v[48:63]
    ds_read_b128 v[144:147], v218 offset:11808
    v_exp_f32 v38, v38
    v_exp_f32 v39, v39
    v_exp_f32 v40, v40
    v_exp_f32 v41, v41
    v_smfmac_f32_32x32x32_bf16 v[96:111], v[132:135], v[32:39], v233
    ds_read_b32 v221, v224
    v_exp_f32 v42, v42
    v_exp_f32 v43, v43
    v_exp_f32 v44, v44
    v_mfma_f32_32x32x16_bf16 v[64:79], v[128:131], v[116:119], v[64:79]
    v_exp_f32 v45, v45
    v_exp_f32 v46, v46
    v_exp_f32 v47, v47
    v_exp_f32 v48, v48
    v_exp_f32 v49, v49
    v_smfmac_f32_32x32x32_bf16 v[96:111], v[140:143], v[40:47], v233
    s_waitcnt lgkmcnt(0)
    v_cmp_eq_u32 vcc, 0, v221
    v_exp_f32 v50, v50
    v_exp_f32 v51, v51
    v_exp_f32 v52, v52
    v_mfma_f32_32x32x4_2b_bf16 v[16:47], v[150:151], v[122:123], 0 cbsz:1 abid:0
    v_exp_f32 v53, v53
    v_exp_f32 v54, v54
    v_exp_f32 v55, v55
    v_exp_f32 v56, v56
    v_exp_f32 v57, v57
    v_exp_f32 v58, v58
    v_exp_f32 v59, v59
    v_exp_f32 v60, v60
    v_smfmac_f32_32x32x32_bf16 v[80:95], v[136:139], v[48:55], v233
    ds_read_b128 v[128:131], v217 offset:15680
    v_exp_f32 v61, v61
    v_exp_f32 v62, v62
    v_exp_f32 v63, v63
    v_exp_f32 v64, v64
    v_exp_f32 v65, v65
    v_smfmac_f32_32x32x32_bf16 v[80:95], v[144:147], v[56:63], v233
    ds_read_b128 v[132:135], v218 offset:13440
    v_exp_f32 v66, v66
    v_exp_f32 v67, v67
    v_exp_f32 v68, v68
    v_exp_f32 v69, v69
    v_mfma_f32_32x32x16_bf16 v[16:31], v[124:127], v[112:115], v[16:31]
    ds_read_b128 v[140:143], v218 offset:14048
    v_exp_f32 v70, v70
    v_exp_f32 v71, v71
    v_exp_f32 v72, v72
    v_exp_f32 v73, v73
    v_smfmac_f32_32x32x32_bf16 v[96:111], v[136:139], v[64:71], v233
    s_cbranch_vccnz L_rw
L_rwd:
    v_exp_f32 v74, v74
    v_exp_f32 v75, v75
    v_exp_f32 v76, v76
    v_mfma_f32_32x32x16_bf16 v[32:47], v[124:127], v[116:119], v[32:47]
    v_add_u32 v217, s70, v219
    v_exp_f32 v77, v77
    v_exp_f32 v78, v78
    v_exp_f32 v79, v79
    v_exp_f32 v16, v16
    v_exp_f32 v17, v17
    v_smfmac_f32_32x32x32_bf16 v[96:111], v[144:147], v[72:79], v233
    s_waitcnt lgkmcnt(0)
    v_exp_f32 v18, v18
    v_exp_f32 v19, v19
    v_exp_f32 v20, v20
    v_mfma_f32_32x32x4_2b_bf16 v[48:79], v[150:151], v[122:123], 0 cbsz:1 abid:1
    v_exp_f32 v21, v21
    v_exp_f32 v22, v22
    v_exp_f32 v23, v23
    v_exp_f32 v24, v24
    v_exp_f32 v25, v25
    v_exp_f32 v26, v26
    v_exp_f32 v27, v27
    v_exp_f32 v28, v28
    v_smfmac_f32_32x32x32_bf16 v[80:95], v[132:135], v[16:23], v233
    ds_read_b128 v[124:127], v217 offset:0
    v_exp_f32 v29, v29
    v_exp_f32 v30, v30
    v_exp_f32 v31, v31
    v_exp_f32 v32, v32
    v_exp_f32 v33, v33
    v_smfmac_f32_32x32x32_bf16 v[80:95], v[140:143], v[24:31], v233
    ds_read_b128 v[136:139], v218 offset:15680
    v_exp_f32 v34, v34
    v_exp_f32 v35, v35
    v_exp_f32 v36, v36
    v_exp_f32 v37, v37
    v_mfma_f32_32x32x16_bf16 v[48:63], v[128:131], v[112:115], v[48:63]
    ds_read_b128 v[144:147], v218 offset:16288
    v_exp_f32 v38, v38
    v_exp_f32 v39, v39
    v_exp_f32 v40, v40
    v_exp_f32 v41, v41
    v_smfmac_f32_32x32x32_bf16 v[96:111], v[132:135], v[32:39], v233
    ds_read_b128 v[148:151], v217 offset:17920
    v_exp_f32 v42, v42
    v_exp_f32 v43, v43
    v_exp_f32 v44, v44
    v_mfma_f32_32x32x16_bf16 v[64:79], v[128:131], v[116:119], v[64:79]
    v_add_u32 v218, s70, v220
    v_add_u32 v224, 4, v224
    v_exp_f32 v45, v45
    v_exp_f32 v46, v46
    v_exp_f32 v47, v47
    v_exp_f32 v48, v48
    v_exp_f32 v49, v49
    v_smfmac_f32_32x32x32_bf16 v[96:111], v[140:143], v[40:47], v233
    s_waitcnt lgkmcnt(0)
    v_exp_f32 v50, v50
    v_exp_f32 v51, v51
    v_exp_f32 v52, v52
    v_mfma_f32_32x32x4_2b_bf16 v[16:47], v[148:149], v[120:121], 0 cbsz:1 abid:0
    v_exp_f32 v53, v53
    v_exp_f32 v54, v54
    v_exp_f32 v55, v55
    v_exp_f32 v56, v56
    v_exp_f32 v57, v57
    v_exp_f32 v58, v58
    v_exp_f32 v59, v59
    v_exp_f32 v60, v60
    v_smfmac_f32_32x32x32_bf16 v[80:95], v[136:139], v[48:55], v233
    ds_read_b128 v[128:131], v217 offset:2240
    v_exp_f32 v61, v61
    v_exp_f32 v62, v62
    v_exp_f32 v63, v63
    v_exp_f32 v64, v64
    v_exp_f32 v65, v65
    v_smfmac_f32_32x32x32_bf16 v[80:95], v[144:147], v[56:63], v233
    ds_read_b128 v[132:135], v218 offset:0
    v_exp_f32 v66, v66
    v_exp_f32 v67, v67
    v_exp_f32 v68, v68
    v_exp_f32 v69, v69
    v_mfma_f32_32x32x16_bf16 v[16:31], v[124:127], v[112:115], v[16:31]
    ds_read_b128 v[140:143], v218 offset:608
    v_exp_f32 v70, v70
    v_exp_f32 v71, v71
    v_exp_f32 v72, v72
    v_exp_f32 v73, v73
    v_smfmac_f32_32x32x32_bf16 v[96:111], v[136:139], v[64:71], v233
    ds_write_b32 v222, v224 offset:48
    v_exp_f32 v74, v74
    v_exp_f32 v75, v75
    v_exp_f32 v76, v76
    v_mfma_f32_32x32x16_bf16 v[32:47], v[124:127], v[116:119], v[32:47]
    s_cmp_lt_u32 s68, 8
    v_exp_f32 v77, v77
    v_exp_f32 v78, v78
    v_exp_f32 v79, v79
    s_cbranch_scc1 L_att
    s_nop 0
    v_smfmac_f32_32x32x32_bf16 v[96:111], v[144:147], v[72:79], v233
    s_setprio 3
    v_mov_b32 v9, s7
    v_mov_b32 v223, 163720
    v_subrev_u32 v2, 562036736, v90
    s_nop 7
    v_subrev_u32 v3, 562036736, v106
    v_max_u32 v2, v2, v3
    v_cmp_lt_u32 vcc, 1006632960, v2
    s_cbranch_vccnz L_slow
L_norm:
    v_rcp_f32 v4, v90
    v_rcp_f32 v6, v106
    v_pk_mul_f32 v[80:81], v[80:81], v[4:5] op_sel_hi:[1,0]
    v_pk_mul_f32 v[82:83], v[82:83], v[4:5] op_sel_hi:[1,0]
    v_pk_mul_f32 v[84:85], v[84:85], v[4:5] op_sel_hi:[1,0]
    v_pk_mul_f32 v[86:87], v[86:87], v[4:5] op_sel_hi:[1,0]
    v_pk_mul_f32 v[88:89], v[88:89], v[4:5] op_sel_hi:[1,0]
    v_cvt_pk_bf16_f32 v152, v80, v81
    v_cvt_pk_bf16_f32 v153, v82, v83
    v_cvt_pk_bf16_f32 v154, v84, v85
    v_cvt_pk_bf16_f32 v155, v86, v87
    v_cvt_pk_bf16_f32 v160, v88, v89
    v_pk_mul_f32 v[96:97], v[96:97], v[6:7] op_sel_hi:[1,0]
    v_pk_mul_f32 v[98:99], v[98:99], v[6:7] op_sel_hi:[1,0]
    v_pk_mul_f32 v[100:101], v[100:101], v[6:7] op_sel_hi:[1,0]
    v_pk_mul_f32 v[102:103], v[102:103], v[6:7] op_sel_hi:[1,0]
    v_pk_mul_f32 v[104:105], v[104:105], v[6:7] op_sel_hi:[1,0]
    v_cvt_pk_bf16_f32 v156, v96, v97
    v_cvt_pk_bf16_f32 v157, v98, v99
    v_cvt_pk_bf16_f32 v158, v100, v101
    v_cvt_pk_bf16_f32 v159, v102, v103
    v_cvt_pk_bf16_f32 v161, v104, v105
    s_cmp_eq_u32 s71, 0
    s_cbranch_scc1 L_pubg
    global_store_dwordx4 v230, v[152:155], s[48:49] offset:0
    global_store_dwordx4 v230, v[156:159], s[48:49] offset:512
    s_mov_b32 exec_hi, 0
    global_store_dwordx2 v231, v[160:161], s[48:49] offset:2048
    s_mov_b64 exec, 1
    s_waitcnt vmcnt(0)
    global_store_dword v232, v9, s[48:49]
    ds_write_b32 v222, v223 offset:48
    s_mov_b64 exec, -1
    s_branch L_fin
L_pubg:
    global_store_dwordx4 v230, v[152:155], s[48:49] offset:0 sc1
    global_store_dwordx4 v230, v[156:159], s[48:49] offset:512 sc1
    s_mov_b32 exec_hi, 0
    global_store_dwordx2 v231, v[160:161], s[48:49] offset:2048 sc1
    s_mov_b64 exec, 1
    s_waitcnt vmcnt(0)
    global_store_dword v232, v9, s[48:49] sc1
    ds_write_b32 v222, v223 offset:48
    s_mov_b64 exec, -1
    s_branch L_fin
L_rw:
    s_sleep 1
    ds_read_b32 v221, v224
    s_waitcnt lgkmcnt(0)
    v_cmp_eq_u32 vcc, 0, v221
    s_cbranch_vccnz L_rw
    s_branch L_rwd
Lspin_10_s:
    s_sleep 1
    s_branch Lspin_10
Lspin_11_s:
    s_sleep 2
    s_branch Lspin_11
Lspin_12_s:
    s_sleep 1
    s_branch Lspin_12
Lspin_13_s:
    s_sleep 1
    s_branch Lspin_13
Lspin_14_s:
    s_sleep 1
    s_branch Lspin_14
Lspin_15_s:
    s_sleep 1
    s_branch Lspin_15
Lspin_16_s:
    s_sleep 1
    s_branch Lspin_16
Lspin_17_s:
    s_sleep 1
    s_branch Lspin_17
Lspin_18_s:
    s_sleep 1
    s_branch Lspin_18
L_kgen:
    s_setprio 1
    s_mul_i32 s77, s68, 8320
    v_and_b32 v2, 1, v1
    v_lshlrev_b32 v2, 4, v2
    v_mov_b32 v3, 0x3f80
    v_lshlrev_b32 v2, v2, v3
    v_bfe_u32 v3, v1, 1, 3
    v_lshrrev_b32 v13, 1, v1
    v_xor_b32 v13, v13, v1
    v_and_b32 v13, 16, v13
    v_or_b32 v3, v3, v13
    v_cmp_eq_u32 vcc, 0, v3
    v_mov_b32 v24, 0
    v_mov_b32 v25, 0
    v_cndmask_b32 v16, 0, v2, vcc
    v_cmp_eq_u32 vcc, 1, v3
    v_mov_b32 v26, 0
    v_mov_b32 v27, 0
    v_cndmask_b32 v17, 0, v2, vcc
    v_cmp_eq_u32 vcc, 2, v3
    v_mov_b32 v28, 0
    v_mov_b32 v29, 0
    v_cndmask_b32 v18, 0, v2, vcc
    v_cmp_eq_u32 vcc, 3, v3
    v_mov_b32 v30, 0
    v_mov_b32 v31, 0
    v_cndmask_b32 v19, 0, v2, vcc
    v_cmp_eq_u32 vcc, 4, v3
    v_mov_b32 v32, 0
    v_mov_b32 v33, 0
    v_cndmask_b32 v20, 0, v2, vcc
    v_cmp_eq_u32 vcc, 5, v3
    v_mov_b32 v34, 0
    v_mov_b32 v35, 0
    v_cndmask_b32 v21, 0, v2, vcc
    v_cmp_eq_u32 vcc, 6, v3
    v_mov_b32 v36, 0
    v_mov_b32 v37, 0
    v_cndmask_b32 v22, 0, v2, vcc
    v_cmp_eq_u32 vcc, 7, v3
    v_mov_b32 v38, 0
    v_mov_b32 v39, 0
    v_cndmask_b32 v23, 0, v2, vcc
    v_mov_b32 v114, 1.0
    v_mov_b32 v115, 0
    s_waitcnt vmcnt(0)
    v_lshlrev_b32 v10, 16, v10
    v_mul_f32 v10, 0x3fb8aa3b, v10
    v_exp_f32 v10, v10
    v_lshlrev_b32 v11, 16, v11
    v_cvt_pk_bf16_f32 v10, v10, v10
    v_lshlrev_b32 v10, 16, v10
    s_mov_b32 s58, 0
L_kround:
    v_lshlrev_b32 v40, 16, v4
    v_lshlrev_b32 v41, 16, v5
    v_lshlrev_b32 v42, 16, v6
    v_lshlrev_b32 v43, 16, v7
    v_lshlrev_b32 v44, 16, v8
    v_lshlrev_b32 v45, 16, v9
    v_lshrrev_b32 v4, 16, v4
    v_lshrrev_b32 v5, 16, v5
    v_lshrrev_b32 v6, 16, v6
    v_lshrrev_b32 v7, 16, v7
    v_lshrrev_b32 v8, 16, v8
    v_lshrrev_b32 v9, 16, v9
    v_mul_f32 v40, v10, v40
    v_mul_f32 v41, v10, v41
    v_mul_f32 v42, v10, v42
    v_mul_f32 v43, v10, v43
    v_mul_f32 v40, 0x3fb8aa3b, v40
    v_mul_f32 v41, 0.15915494, v41
    v_mul_f32 v52, 0x41000000, v40
    v_mul_f32 v53, 0x41000000, v41
    v_exp_f32 v52, v52
    v_fract_f32 v53, v53
    v_cos_f32 v48, v53
    v_sin_f32 v49, v53
    v_mul_f32 v48, v52, v48
    v_mul_f32 v49, v52, v49
    v_mul_f32 v52, 0x3f800000, v40
    v_mul_f32 v53, 0x3f800000, v41
    v_exp_f32 v52, v52
    v_fract_f32 v53, v53
    v_cos_f32 v46, v53
    v_sin_f32 v47, v53
    v_mul_f32 v46, v52, v46
    v_mul_f32 v47, v52, v47
    v_mul_f32 v52, 0x43800000, v40
    v_mul_f32 v53, 0x43800000, v41
    v_exp_f32 v52, v52
    v_fract_f32 v53, v53
    v_cos_f32 v50, v53
    v_sin_f32 v51, v53
    v_mul_f32 v50, v52, v50
    v_mul_f32 v51, v52, v51
    v_cvt_pk_bf16_f32 v148, v114, v48
    v_cvt_pk_bf16_f32 v164, v115, v49
    v_pk_mul_f32 v[54:55], v[44:45], v[42:43] op_sel:[0,0] op_sel_hi:[0,1]
    v_pk_fma_f32 v[54:55], v[44:45], v[42:43], v[54:55] op_sel:[1,1,0] op_sel_hi:[1,0,1] neg_lo:[0,1,0]
    v_pk_mul_f32 v[110:111], v[48:49], v[48:49] op_sel:[0,0] op_sel_hi:[0,1]
    v_pk_fma_f32 v[110:111], v[48:49], v[48:49], v[110:111] op_sel:[1,1,0] op_sel_hi:[1,0,1] neg_lo:[0,1,0]
    v_pk_mul_f32 v[56:57], v[54:55], v[46:47] op_sel:[0,0] op_sel_hi:[0,1]
    v_pk_fma_f32 v[56:57], v[54:55], v[46:47], v[56:57] op_sel:[1,1,0] op_sel_hi:[1,0,1] neg_lo:[0,1,0]
    v_pk_mul_f32 v[112:113], v[110:111], v[48:49] op_sel:[0,0] op_sel_hi:[0,1]
    v_pk_fma_f32 v[112:113], v[110:111], v[48:49], v[112:113] op_sel:[1,1,0] op_sel_hi:[1,0,1] neg_lo:[0,1,0]
    v_cvt_pk_bf16_f32 v149, v110, v112
    v_cvt_pk_bf16_f32 v165, v111, v113
    v_pk_mul_f32 v[58:59], v[56:57], v[46:47] op_sel:[0,0] op_sel_hi:[0,1]
    v_pk_fma_f32 v[58:59], v[56:57], v[46:47], v[58:59] op_sel:[1,1,0] op_sel_hi:[1,0,1] neg_lo:[0,1,0]
    v_pk_mul_f32 v[110:111], v[112:113], v[48:49] op_sel:[0,0] op_sel_hi:[0,1]
    v_pk_fma_f32 v[110:111], v[112:113], v[48:49], v[110:111] op_sel:[1,1,0] op_sel_hi:[1,0,1] neg_lo:[0,1,0]
    v_pk_mul_f32 v[60:61], v[58:59], v[46:47] op_sel:[0,0] op_sel_hi:[0,1]
    v_pk_fma_f32 v[60:61], v[58:59], v[46:47], v[60:61] op_sel:[1,1,0] op_sel_hi:[1,0,1] neg_lo:[0,1,0]
    v_pk_mul_f32 v[112:113], v[110:111], v[48:49] op_sel:[0,0] op_sel_hi:[0,1]
    v_pk_fma_f32 v[112:113], v[110:111], v[48:49], v[112:113] op_sel:[1,1,0] op_sel_hi:[1,0,1] neg_lo:[0,1,0]
    v_cvt_pk_bf16_f32 v150, v110, v112
    v_cvt_pk_bf16_f32 v166, v111, v113
    v_pk_mul_f32 v[62:63], v[60:61], v[46:47] op_sel:[0,0] op_sel_hi:[0,1]
    v_pk_fma_f32 v[62:63], v[60:61], v[46:47], v[62:63] op_sel:[1,1,0] op_sel_hi:[1,0,1] neg_lo:[0,1,0]
    v_pk_mul_f32 v[110:111], v[112:113], v[48:49] op_sel:[0,0] op_sel_hi:[0,1]
    v_pk_fma_f32 v[110:111], v[112:113], v[48:49], v[110:111] op_sel:[1,1,0] op_sel_hi:[1,0,1] neg_lo:[0,1,0]
    v_pk_mul_f32 v[64:65], v[62:63], v[46:47] op_sel:[0,0] op_sel_hi:[0,1]
    v_pk_fma_f32 v[64:65], v[62:63], v[46:47], v[64:65] op_sel:[1,1,0] op_sel_hi:[1,0,1] neg_lo:[0,1,0]
    v_pk_mul_f32 v[112:113], v[110:111], v[48:49] op_sel:[0,0] op_sel_hi:[0,1]
    v_pk_fma_f32 v[112:113], v[110:111], v[48:49], v[112:113] op_sel:[1,1,0] op_sel_hi:[1,0,1] neg_lo:[0,1,0]
    v_cvt_pk_bf16_f32 v151, v110, v112
    v_cvt_pk_bf16_f32 v167, v111, v113
    v_pk_mul_f32 v[66:67], v[64:65], v[46:47] op_sel:[0,0] op_sel_hi:[0,1]
    v_pk_fma_f32 v[66:67], v[64:65], v[46:47], v[66:67] op_sel:[1,1,0] op_sel_hi:[1,0,1] neg_lo:[0,1,0]
    v_pk_mul_f32 v[110:111], v[112:113], v[48:49] op_sel:[0,0] op_sel_hi:[0,1]
    v_pk_fma_f32 v[110:111], v[112:113], v[48:49], v[110:111] op_sel:[1,1,0] op_sel_hi:[1,0,1] neg_lo:[0,1,0]
    v_pk_mul_f32 v[68:69], v[66:67], v[46:47] op_sel:[0,0] op_sel_hi:[0,1]
    v_pk_fma_f32 v[68:69], v[66:67], v[46:47], v[68:69] op_sel:[1,1,0] op_sel_hi:[1,0,1] neg_lo:[0,1,0]
    v_mfma_f32_32x32x16_bf16 v[180:195], v[148:151], v[16:19], 0
    v_pk_mul_f32 v[112:113], v[110:111], v[48:49] op_sel:[0,0] op_sel_hi:[0,1]
    v_pk_fma_f32 v[112:113], v[110:111], v[48:49], v[112:113] op_sel:[1,1,0] op_sel_hi:[1,0,1] neg_lo:[0,1,0]
    v_cvt_pk_bf16_f32 v152, v110, v112
    v_cvt_pk_bf16_f32 v168, v111, v113
    v_pk_mul_f32 v[70:71], v[68:69], v[46:47] op_sel:[0,0] op_sel_hi:[0,1]
    v_pk_fma_f32 v[70:71], v[68:69], v[46:47], v[70:71] op_sel:[1,1,0] op_sel_hi:[1,0,1] neg_lo:[0,1,0]
    v_pk_mul_f32 v[110:111], v[112:113], v[48:49] op_sel:[0,0] op_sel_hi:[0,1]
    v_pk_fma_f32 v[110:111], v[112:113], v[48:49], v[110:111] op_sel:[1,1,0] op_sel_hi:[1,0,1] neg_lo:[0,1,0]
    v_pk_mul_f32 v[72:73], v[54:55], v[50:51] op_sel:[0,0] op_sel_hi:[0,1]
    v_pk_fma_f32 v[72:73], v[54:55], v[50:51], v[72:73] op_sel:[1,1,0] op_sel_hi:[1,0,1] neg_lo:[0,1,0]
    v_mfma_f32_32x32x16_bf16 v[212:227], v[164:167], v[16:19], 0
    v_pk_mul_f32 v[112:113], v[110:111], v[48:49] op_sel:[0,0] op_sel_hi:[0,1]
    v_pk_fma_f32 v[112:113], v[110:111], v[48:49], v[112:113] op_sel:[1,1,0] op_sel_hi:[1,0,1] neg_lo:[0,1,0]
    v_cvt_pk_bf16_f32 v153, v110, v112
    v_cvt_pk_bf16_f32 v169, v111, v113
    v_pk_mul_f32 v[74:75], v[58:59], v[50:51] op_sel:[0,0] op_sel_hi:[0,1]
    v_pk_fma_f32 v[74:75], v[58:59], v[50:51], v[74:75] op_sel:[1,1,0] op_sel_hi:[1,0,1] neg_lo:[0,1,0]
    v_pk_mul_f32 v[110:111], v[112:113], v[48:49] op_sel:[0,0] op_sel_hi:[0,1]
    v_pk_fma_f32 v[110:111], v[112:113], v[48:49], v[110:111] op_sel:[1,1,0] op_sel_hi:[1,0,1] neg_lo:[0,1,0]
    v_pk_mul_f32 v[76:77], v[62:63], v[50:51] op_sel:[0,0] op_sel_hi:[0,1]
    v_pk_fma_f32 v[76:77], v[62:63], v[50:51], v[76:77] op_sel:[1,1,0] op_sel_hi:[1,0,1] neg_lo:[0,1,0]
    v_pk_mul_f32 v[112:113], v[110:111], v[48:49] op_sel:[0,0] op_sel_hi:[0,1]
    v_pk_fma_f32 v[112:113], v[110:111], v[48:49], v[112:113] op_sel:[1,1,0] op_sel_hi:[1,0,1] neg_lo:[0,1,0]
    v_cvt_pk_bf16_f32 v154, v110, v112
    v_cvt_pk_bf16_f32 v170, v111, v113
    v_pk_mul_f32 v[78:79], v[66:67], v[50:51] op_sel:[0,0] op_sel_hi:[0,1]
    v_pk_fma_f32 v[78:79], v[66:67], v[50:51], v[78:79] op_sel:[1,1,0] op_sel_hi:[1,0,1] neg_lo:[0,1,0]
    v_pk_mul_f32 v[110:111], v[112:113], v[48:49] op_sel:[0,0] op_sel_hi:[0,1]
    v_pk_fma_f32 v[110:111], v[112:113], v[48:49], v[110:111] op_sel:[1,1,0] op_sel_hi:[1,0,1] neg_lo:[0,1,0]
    v_pk_mul_f32 v[80:81], v[70:71], v[50:51] op_sel:[0,0] op_sel_hi:[0,1]
    v_pk_fma_f32 v[80:81], v[70:71], v[50:51], v[80:81] op_sel:[1,1,0] op_sel_hi:[1,0,1] neg_lo:[0,1,0]
    v_pk_mul_f32 v[112:113], v[110:111], v[48:49] op_sel:[0,0] op_sel_hi:[0,1]
    v_pk_fma_f32 v[112:113], v[110:111], v[48:49], v[112:113] op_sel:[1,1,0] op_sel_hi:[1,0,1] neg_lo:[0,1,0]
    v_cvt_pk_bf16_f32 v155, v110, v112
    v_cvt_pk_bf16_f32 v171, v111, v113
    v_pk_mul_f32 v[82:83], v[72:73], v[50:51] op_sel:[0,0] op_sel_hi:[0,1]
    v_pk_fma_f32 v[82:83], v[72:73], v[50:51], v[82:83] op_sel:[1,1,0] op_sel_hi:[1,0,1] neg_lo:[0,1,0]
    v_pk_mul_f32 v[110:111], v[112:113], v[48:49] op_sel:[0,0] op_sel_hi:[0,1]
    v_pk_fma_f32 v[110:111], v[112:113], v[48:49], v[110:111] op_sel:[1,1,0] op_sel_hi:[1,0,1] neg_lo:[0,1,0]
    v_pk_mul_f32 v[84:85], v[76:77], v[50:51] op_sel:[0,0] op_sel_hi:[0,1]
    v_pk_fma_f32 v[84:85], v[76:77], v[50:51], v[84:85] op_sel:[1,1,0] op_sel_hi:[1,0,1] neg_lo:[0,1,0]
    v_mfma_f32_32x32x16_bf16 v[180:195], v[152:155], v[20:23], v[180:195]
    v_pk_mul_f32 v[112:113], v[110:111], v[48:49] op_sel:[0,0] op_sel_hi:[0,1]
    v_pk_fma_f32 v[112:113], v[110:111], v[48:49], v[112:113] op_sel:[1,1,0] op_sel_hi:[1,0,1] neg_lo:[0,1,0]
    v_cvt_pk_bf16_f32 v156, v110, v112
    v_cvt_pk_bf16_f32 v172, v111, v113
    v_pk_mul_f32 v[86:87], v[80:81], v[50:51] op_sel:[0,0] op_sel_hi:[0,1]
    v_pk_fma_f32 v[86:87], v[80:81], v[50:51], v[86:87] op_sel:[1,1,0] op_sel_hi:[1,0,1] neg_lo:[0,1,0]
    v_pk_mul_f32 v[110:111], v[112:113], v[48:49] op_sel:[0,0] op_sel_hi:[0,1]
    v_pk_fma_f32 v[110:111], v[112:113], v[48:49], v[110:111] op_sel:[1,1,0] op_sel_hi:[1,0,1] neg_lo:[0,1,0]
    v_pk_mul_f32 v[88:89], v[82:83], v[50:51] op_sel:[0,0] op_sel_hi:[0,1]
    v_pk_fma_f32 v[88:89], v[82:83], v[50:51], v[88:89] op_sel:[1,1,0] op_sel_hi:[1,0,1] neg_lo:[0,1,0]
    v_mfma_f32_32x32x16_bf16 v[212:227], v[168:171], v[20:23], v[212:227]
    v_pk_mul_f32 v[112:113], v[110:111], v[48:49] op_sel:[0,0] op_sel_hi:[0,1]
    v_pk_fma_f32 v[112:113], v[110:111], v[48:49], v[112:113] op_sel:[1,1,0] op_sel_hi:[1,0,1] neg_lo:[0,1,0]
    v_cvt_pk_bf16_f32 v157, v110, v112
    v_cvt_pk_bf16_f32 v173, v111, v113
    v_pk_mul_f32 v[90:91], v[84:85], v[50:51] op_sel:[0,0] op_sel_hi:[0,1]
    v_pk_fma_f32 v[90:91], v[84:85], v[50:51], v[90:91] op_sel:[1,1,0] op_sel_hi:[1,0,1] neg_lo:[0,1,0]
    v_pk_mul_f32 v[110:111], v[112:113], v[48:49] op_sel:[0,0] op_sel_hi:[0,1]
    v_pk_fma_f32 v[110:111], v[112:113], v[48:49], v[110:111] op_sel:[1,1,0] op_sel_hi:[1,0,1] neg_lo:[0,1,0]
    v_pk_mul_f32 v[92:93], v[86:87], v[50:51] op_sel:[0,0] op_sel_hi:[0,1]
    v_pk_fma_f32 v[92:93], v[86:87], v[50:51], v[92:93] op_sel:[1,1,0] op_sel_hi:[1,0,1] neg_lo:[0,1,0]
    v_pk_mul_f32 v[112:113], v[110:111], v[48:49] op_sel:[0,0] op_sel_hi:[0,1]
    v_pk_fma_f32 v[112:113], v[110:111], v[48:49], v[112:113] op_sel:[1,1,0] op_sel_hi:[1,0,1] neg_lo:[0,1,0]
    v_cvt_pk_bf16_f32 v158, v110, v112
    v_cvt_pk_bf16_f32 v174, v111, v113
    v_pk_mul_f32 v[94:95], v[88:89], v[50:51] op_sel:[0,0] op_sel_hi:[0,1]
    v_pk_fma_f32 v[94:95], v[88:89], v[50:51], v[94:95] op_sel:[1,1,0] op_sel_hi:[1,0,1] neg_lo:[0,1,0]
    v_pk_mul_f32 v[110:111], v[112:113], v[48:49] op_sel:[0,0] op_sel_hi:[0,1]
    v_pk_fma_f32 v[110:111], v[112:113], v[48:49], v[110:111] op_sel:[1,1,0] op_sel_hi:[1,0,1] neg_lo:[0,1,0]
    v_pk_mul_f32 v[96:97], v[92:93], v[50:51] op_sel:[0,0] op_sel_hi:[0,1]
    v_pk_fma_f32 v[96:97], v[92:93], v[50:51], v[96:97] op_sel:[1,1,0] op_sel_hi:[1,0,1] neg_lo:[0,1,0]
    v_pk_mul_f32 v[112:113], v[110:111], v[48:49] op_sel:[0,0] op_sel_hi:[0,1]
    v_pk_fma_f32 v[112:113], v[110:111], v[48:49], v[112:113] op_sel:[1,1,0] op_sel_hi:[1,0,1] neg_lo:[0,1,0]
    v_cvt_pk_bf16_f32 v159, v110, v112
    v_cvt_pk_bf16_f32 v175, v111, v113
    v_pk_mul_f32 v[98:99], v[94:95], v[50:51] op_sel:[0,0] op_sel_hi:[0,1]
    v_pk_fma_f32 v[98:99], v[94:95], v[50:51], v[98:99] op_sel:[1,1,0] op_sel_hi:[1,0,1] neg_lo:[0,1,0]
    v_pk_mul_f32 v[110:111], v[112:113], v[48:49] op_sel:[0,0] op_sel_hi:[0,1]
    v_pk_fma_f32 v[110:111], v[112:113], v[48:49], v[110:111] op_sel:[1,1,0] op_sel_hi:[1,0,1] neg_lo:[0,1,0]
    v_pk_mul_f32 v[100:101], v[96:97], v[50:51] op_sel:[0,0] op_sel_hi:[0,1]
    v_pk_fma_f32 v[100:101], v[96:97], v[50:51], v[100:101] op_sel:[1,1,0] op_sel_hi:[1,0,1] neg_lo:[0,1,0]
    v_mfma_f32_32x32x16_bf16 v[196:211], v[156:159], v[16:19], 0
    v_pk_mul_f32 v[112:113], v[110:111], v[48:49] op_sel:[0,0] op_sel_hi:[0,1]
    v_pk_fma_f32 v[112:113], v[110:111], v[48:49], v[112:113] op_sel:[1,1,0] op_sel_hi:[1,0,1] neg_lo:[0,1,0]
    v_cvt_pk_bf16_f32 v160, v110, v112
    v_cvt_pk_bf16_f32 v176, v111, v113
    v_pk_mul_f32 v[102:103], v[98:99], v[50:51] op_sel:[0,0] op_sel_hi:[0,1]
    v_pk_fma_f32 v[102:103], v[98:99], v[50:51], v[102:103] op_sel:[1,1,0] op_sel_hi:[1,0,1] neg_lo:[0,1,0]
    v_pk_mul_f32 v[110:111], v[112:113], v[48:49] op_sel:[0,0] op_sel_hi:[0,1]
    v_pk_fma_f32 v[110:111], v[112:113], v[48:49], v[110:111] op_sel:[1,1,0] op_sel_hi:[1,0,1] neg_lo:[0,1,0]
    v_pk_mul_f32 v[104:105], v[100:101], v[50:51] op_sel:[0,0] op_sel_hi:[0,1]
    v_pk_fma_f32 v[104:105], v[100:101], v[50:51], v[104:105] op_sel:[1,1,0] op_sel_hi:[1,0,1] neg_lo:[0,1,0]
    v_mfma_f32_32x32x16_bf16 v[228:243], v[172:175], v[16:19], 0
    v_pk_mul_f32 v[112:113], v[110:111], v[48:49] op_sel:[0,0] op_sel_hi:[0,1]
    v_pk_fma_f32 v[112:113], v[110:111], v[48:49], v[112:113] op_sel:[1,1,0] op_sel_hi:[1,0,1] neg_lo:[0,1,0]
    v_cvt_pk_bf16_f32 v161, v110, v112
    v_cvt_pk_bf16_f32 v177, v111, v113
    v_pk_mul_f32 v[106:107], v[102:103], v[50:51] op_sel:[0,0] op_sel_hi:[0,1]
    v_pk_fma_f32 v[106:107], v[102:103], v[50:51], v[106:107] op_sel:[1,1,0] op_sel_hi:[1,0,1] neg_lo:[0,1,0]
    v_pk_mul_f32 v[110:111], v[112:113], v[48:49] op_sel:[0,0] op_sel_hi:[0,1]
    v_pk_fma_f32 v[110:111], v[112:113], v[48:49], v[110:111] op_sel:[1,1,0] op_sel_hi:[1,0,1] neg_lo:[0,1,0]
    v_pk_mul_f32 v[108:109], v[104:105], v[50:51] op_sel:[0,0] op_sel_hi:[0,1]
    v_pk_fma_f32 v[108:109], v[104:105], v[50:51], v[108:109] op_sel:[1,1,0] op_sel_hi:[1,0,1] neg_lo:[0,1,0]
    v_pk_mul_f32 v[112:113], v[110:111], v[48:49] op_sel:[0,0] op_sel_hi:[0,1]
    v_pk_fma_f32 v[112:113], v[110:111], v[48:49], v[112:113] op_sel:[1,1,0] op_sel_hi:[1,0,1] neg_lo:[0,1,0]
    v_cvt_pk_bf16_f32 v162, v110, v112
    v_cvt_pk_bf16_f32 v178, v111, v113
    v_pk_mul_f32 v[110:111], v[112:113], v[48:49] op_sel:[0,0] op_sel_hi:[0,1]
    v_pk_fma_f32 v[110:111], v[112:113], v[48:49], v[110:111] op_sel:[1,1,0] op_sel_hi:[1,0,1] neg_lo:[0,1,0]
    v_pk_mul_f32 v[112:113], v[110:111], v[48:49] op_sel:[0,0] op_sel_hi:[0,1]
    v_pk_fma_f32 v[112:113], v[110:111], v[48:49], v[112:113] op_sel:[1,1,0] op_sel_hi:[1,0,1] neg_lo:[0,1,0]
    v_cvt_pk_bf16_f32 v163, v110, v112
    v_cvt_pk_bf16_f32 v179, v111, v113
    v_cvt_pk_bf16_f32 v116, v54, v56
    v_cvt_pk_bf16_f32 v132, -v55, -v57
    v_cvt_pk_bf16_f32 v117, v58, v60
    v_cvt_pk_bf16_f32 v133, -v59, -v61
    v_mfma_f32_32x32x16_bf16 v[196:211], v[160:163], v[20:23], v[196:211]
    v_cvt_pk_bf16_f32 v118, v72, v72
    v_cvt_pk_bf16_f32 v134, -v73, -v73
    v_cvt_pk_bf16_f32 v119, v74, v76
    v_cvt_pk_bf16_f32 v135, -v75, -v77
    v_cvt_pk_bf16_f32 v120, v82, v84
    v_cvt_pk_bf16_f32 v136, -v83, -v85
    v_mfma_f32_32x32x16_bf16 v[228:243], v[176:179], v[20:23], v[228:243]
    v_cvt_pk_bf16_f32 v121, v86, v86
    v_cvt_pk_bf16_f32 v137, -v87, -v87
    v_cvt_pk_bf16_f32 v122, v88, v90
    v_cvt_pk_bf16_f32 v138, -v89, -v91
    v_cvt_pk_bf16_f32 v123, v92, v92
    v_cvt_pk_bf16_f32 v139, -v93, -v93
    v_cvt_pk_bf16_f32 v148, v180, v181
    v_cvt_pk_bf16_f32 v149, v182, v183
    v_cvt_pk_bf16_f32 v150, v184, v185
    v_cvt_pk_bf16_f32 v151, v186, v187
    v_cvt_pk_bf16_f32 v152, v188, v189
    v_cvt_pk_bf16_f32 v153, v190, v191
    v_cvt_pk_bf16_f32 v154, v192, v193
    v_cvt_pk_bf16_f32 v155, v194, v195
    v_mfma_f32_32x32x16_bf16 v[180:195], v[116:119], v[16:19], 0
    v_cvt_pk_bf16_f32 v164, v212, v213
    v_cvt_pk_bf16_f32 v165, v214, v215
    v_cvt_pk_bf16_f32 v166, v216, v217
    v_cvt_pk_bf16_f32 v167, v218, v219
    v_cvt_pk_bf16_f32 v168, v220, v221
    v_cvt_pk_bf16_f32 v169, v222, v223
    v_cvt_pk_bf16_f32 v170, v224, v225
    v_cvt_pk_bf16_f32 v171, v226, v227
    v_mfma_f32_32x32x16_bf16 v[212:227], v[132:135], v[16:19], 0
    v_cvt_pk_bf16_f32 v124, v62, v64
    v_cvt_pk_bf16_f32 v140, -v63, -v65
    v_cvt_pk_bf16_f32 v125, v66, v68
    v_cvt_pk_bf16_f32 v141, -v67, -v69
    v_cvt_pk_bf16_f32 v126, v76, v76
    v_cvt_pk_bf16_f32 v142, -v77, -v77
    v_cvt_pk_bf16_f32 v127, v78, v80
    v_cvt_pk_bf16_f32 v143, -v79, -v81
    v_mfma_f32_32x32x16_bf16 v[180:195], v[120:123], v[20:23], v[180:195]
    v_cvt_pk_bf16_f32 v128, v94, v96
    v_cvt_pk_bf16_f32 v144, -v95, -v97
    v_cvt_pk_bf16_f32 v129, v102, v104
    v_cvt_pk_bf16_f32 v145, -v103, -v105
    v_cvt_pk_bf16_f32 v130, v98, v100
    v_cvt_pk_bf16_f32 v146, -v99, -v101
    v_cvt_pk_bf16_f32 v131, v106, v108
    v_cvt_pk_bf16_f32 v147, -v107, -v109
    v_mfma_f32_32x32x16_bf16 v[212:227], v[136:139], v[20:23], v[212:227]
    v_cvt_pk_bf16_f32 v156, v196, v197
    v_cvt_pk_bf16_f32 v157, v198, v199
    v_cvt_pk_bf16_f32 v158, v200, v201
    v_cvt_pk_bf16_f32 v159, v202, v203
    v_cvt_pk_bf16_f32 v160, v204, v205
    v_cvt_pk_bf16_f32 v161, v206, v207
    v_cvt_pk_bf16_f32 v162, v208, v209
    v_cvt_pk_bf16_f32 v163, v210, v211
    v_mfma_f32_32x32x16_bf16 v[196:211], v[124:127], v[16:19], 0
    v_cvt_pk_bf16_f32 v172, v228, v229
    v_cvt_pk_bf16_f32 v173, v230, v231
    v_cvt_pk_bf16_f32 v174, v232, v233
    v_cvt_pk_bf16_f32 v175, v234, v235
    v_cvt_pk_bf16_f32 v176, v236, v237
    v_cvt_pk_bf16_f32 v177, v238, v239
    v_cvt_pk_bf16_f32 v178, v240, v241
    v_cvt_pk_bf16_f32 v179, v242, v243
    v_mfma_f32_32x32x16_bf16 v[228:243], v[140:143], v[16:19], 0
    v_cvt_pk_bf16_f32 v116, v180, v181
    v_cvt_pk_bf16_f32 v117, v182, v183
    v_cvt_pk_bf16_f32 v118, v184, v185
    v_cvt_pk_bf16_f32 v119, v186, v187
    v_cvt_pk_bf16_f32 v120, v188, v189
    v_cvt_pk_bf16_f32 v121, v190, v191
    v_cvt_pk_bf16_f32 v122, v192, v193
    v_cvt_pk_bf16_f32 v123, v194, v195
    v_mfma_f32_32x32x16_bf16 v[196:211], v[128:131], v[20:23], v[196:211]
    v_cvt_pk_bf16_f32 v132, v212, v213
    v_cvt_pk_bf16_f32 v133, v214, v215
    v_cvt_pk_bf16_f32 v134, v216, v217
    v_cvt_pk_bf16_f32 v135, v218, v219
    v_cvt_pk_bf16_f32 v136, v220, v221
    v_cvt_pk_bf16_f32 v137, v222, v223
    v_cvt_pk_bf16_f32 v138, v224, v225
    v_cvt_pk_bf16_f32 v139, v226, v227
    v_mfma_f32_32x32x16_bf16 v[228:243], v[144:147], v[20:23], v[228:243]
    v_mfma_f32_16x16x32_bf16 v[24:27], v[116:119], v[148:151], v[24:27]
    v_mfma_f32_16x16x32_bf16 v[28:31], v[116:119], v[156:159], v[28:31]
    v_mfma_f32_16x16x32_bf16 v[24:27], v[120:123], v[152:155], v[24:27]
    v_mfma_f32_16x16x32_bf16 v[28:31], v[120:123], v[160:163], v[28:31]
    v_mfma_f32_16x16x32_bf16 v[24:27], v[132:135], v[164:167], v[24:27]
    v_mfma_f32_16x16x32_bf16 v[28:31], v[132:135], v[172:175], v[28:31]
    v_mfma_f32_16x16x32_bf16 v[24:27], v[136:139], v[168:171], v[24:27]
    v_mfma_f32_16x16x32_bf16 v[28:31], v[136:139], v[176:179], v[28:31]
    v_cvt_pk_bf16_f32 v124, v196, v197
    v_cvt_pk_bf16_f32 v125, v198, v199
    v_cvt_pk_bf16_f32 v126, v200, v201
    v_cvt_pk_bf16_f32 v127, v202, v203
    v_cvt_pk_bf16_f32 v128, v204, v205
    v_cvt_pk_bf16_f32 v129, v206, v207
    v_cvt_pk_bf16_f32 v130, v208, v209
    v_cvt_pk_bf16_f32 v131, v210, v211
    v_cvt_pk_bf16_f32 v140, v228, v229
    v_cvt_pk_bf16_f32 v141, v230, v231
    v_cvt_pk_bf16_f32 v142, v232, v233
    v_cvt_pk_bf16_f32 v143, v234, v235
    v_cvt_pk_bf16_f32 v144, v236, v237
    v_cvt_pk_bf16_f32 v145, v238, v239
    v_cvt_pk_bf16_f32 v146, v240, v241
    v_cvt_pk_bf16_f32 v147, v242, v243
    v_mfma_f32_16x16x32_bf16 v[32:35], v[124:127], v[148:151], v[32:35]
    v_mfma_f32_16x16x32_bf16 v[36:39], v[124:127], v[156:159], v[36:39]
    v_mfma_f32_16x16x32_bf16 v[32:35], v[128:131], v[152:155], v[32:35]
    v_mfma_f32_16x16x32_bf16 v[36:39], v[128:131], v[160:163], v[36:39]
    v_mfma_f32_16x16x32_bf16 v[32:35], v[140:143], v[164:167], v[32:35]
    v_mfma_f32_16x16x32_bf16 v[36:39], v[140:143], v[172:175], v[36:39]
    v_mfma_f32_16x16x32_bf16 v[32:35], v[144:147], v[168:171], v[32:35]
    v_mfma_f32_16x16x32_bf16 v[36:39], v[144:147], v[176:179], v[36:39]
    s_add_u32 s58, s58, 1
    s_cmp_lt_u32 s58, 2
    s_cbranch_scc1 L_kround
    v_and_b32 v2, 15, v1
    v_lshrrev_b32 v3, 4, v1
    v_lshl_add_u32 v2, v2, 4, s77
    v_lshl_add_u32 v6, v3, 9, v2
    v_and_b32 v4, 1, v3
    v_lshl_add_u32 v7, v4, 9, v2
    v_lshrrev_b32 v4, 1, v3
    v_lshlrev_b32 v4, 8, v4
    v_sub_u32 v7, v7, v4
    v_add_u32 v7, 256, v7
    s_mov_b64 exec, 1
    v_add_f32 v24, v24, v11
    s_mov_b32 exec_lo, -1
    v_cvt_pk_bf16_f32 v40, v24, v25
    v_cvt_pk_bf16_f32 v41, v26, v27
    v_cvt_pk_bf16_f32 v42, v32, v33
    v_cvt_pk_bf16_f32 v43, v34, v35
    v_cvt_pk_bf16_f32 v44, v28, v29
    v_cvt_pk_bf16_f32 v45, v30, v31
    v_cvt_pk_bf16_f32 v46, v36, v37
    v_cvt_pk_bf16_f32 v47, v38, v39
    s_not_b64 exec, exec
    v_cvt_pk_bf16_f32 v40, v24, v24
    v_cvt_pk_bf16_f32 v41, v24, v25
    v_cvt_pk_bf16_f32 v42, v25, v25
    v_cvt_pk_bf16_f32 v43, v26, v26
    v_cvt_pk_bf16_f32 v44, v28, v28
    v_cvt_pk_bf16_f32 v45, v28, v29
    v_cvt_pk_bf16_f32 v46, v29, v29
    v_cvt_pk_bf16_f32 v47, v30, v30
    s_mov_b64 exec, -1
    v_permlane32_swap_b32 v36, v32
    v_permlane32_swap_b32 v37, v33
    v_permlane32_swap_b32 v38, v34
    v_permlane32_swap_b32 v39, v35
    s_mov_b32 vcc_lo, 0xaaaaaaaa
    s_mov_b32 vcc_hi, 0xaaaaaaaa
    v_cndmask_b32 v4, v32, v33, vcc
    v_cvt_pk_bf16_f32 v48, v32, v32
    v_cvt_pk_bf16_f32 v49, v32, v32
    v_cvt_pk_bf16_f32 v50, v4, v33
    v_cvt_pk_bf16_f32 v51, v33, v33
    v_cndmask_b32 v4, v34, v35, vcc
    v_cvt_pk_bf16_f32 v52, v34, v34
    v_cvt_pk_bf16_f32 v53, v34, v34
    v_cvt_pk_bf16_f32 v54, v4, v35
    v_cvt_pk_bf16_f32 v55, v35, v35
    v_mov_b32 v56, 0
    v_mov_b32 v57, 0
    v_mov_b32 v58, 0
    v_mov_b32 v59, 0
    v_lshl_add_u32 v8, v1, 4, s77
    v_cmp_eq_u32 vcc, 2, v1
    v_add_u32 v9, 4128, v8
    s_nop 0
    v_cndmask_b32 v9, v8, v9, vcc
    v_lshlrev_b32 v252, 4, v1
    v_and_b32 v200, 3, v1
    v_lshl_add_u32 v250, v200, 2, v253
    v_subrev_u32 v200, 256, v0
    v_lshrrev_b32 v200, 1, v200
    v_mul_u32_u24 v201, 1152, v200
    s_lshl_b32 s64, s50, 1
    s_and_b32 s65, s51, -2
    s_lshl_b32 s65, s65, 1
    s_sub_u32 s65, s65, s64
    v_and_b32 v202, 1, v1
    v_mul_lo_u32 v203, v202, s65
    v_add3_u32 v251, v201, v203, s64
    v_mul_u32_u24 v203, 9216, v202
    v_lshlrev_b32 v200, 1, v200
    v_sub_u32 v200, v203, v200
    v_add_u32 v200, 29054, v200
    s_lshl_b32 s72, s6, 1
    s_add_u32 s64, s72, 0
    s_and_b32 s64, s64, 15
    s_lshl_b32 s64, s64, 8
    v_subrev_u32 v210, s64, v200
    s_add_u32 s64, s72, 1
    s_and_b32 s64, s64, 15
    s_lshl_b32 s64, s64, 8
    v_subrev_u32 v211, s64, v200
    s_add_u32 s64, s72, 2
    s_and_b32 s64, s64, 15
    s_lshl_b32 s64, s64, 8
    v_subrev_u32 v212, s64, v200
    s_add_u32 s64, s72, 3
    s_and_b32 s64, s64, 15
    s_lshl_b32 s64, s64, 8
    v_subrev_u32 v213, s64, v200
    s_add_u32 s64, s72, 4
    s_and_b32 s64, s64, 15
    s_lshl_b32 s64, s64, 8
    v_subrev_u32 v214, s64, v200
    s_add_u32 s64, s72, 5
    s_and_b32 s64, s64, 15
    s_lshl_b32 s64, s64, 8
    v_subrev_u32 v215, s64, v200
    s_add_u32 s64, s72, 6
    s_and_b32 s64, s64, 15
    s_lshl_b32 s64, s64, 8
    v_subrev_u32 v216, s64, v200
    s_add_u32 s64, s72, 7
    s_and_b32 s64, s64, 15
    s_lshl_b32 s64, s64, 8
    v_subrev_u32 v217, s64, v200
    s_add_u32 s64, s72, 8
    s_and_b32 s64, s64, 15
    s_lshl_b32 s64, s64, 8
    v_subrev_u32 v218, s64, v200
    s_add_u32 s64, s72, 9
    s_and_b32 s64, s64, 15
    s_lshl_b32 s64, s64, 8
    v_subrev_u32 v219, s64, v200
    s_add_u32 s64, s72, 10
    s_and_b32 s64, s64, 15
    s_lshl_b32 s64, s64, 8
    v_subrev_u32 v220, s64, v200
    s_add_u32 s64, s72, 11
    s_and_b32 s64, s64, 15
    s_lshl_b32 s64, s64, 8
    v_subrev_u32 v221, s64, v200
    s_add_u32 s64, s72, 12
    s_and_b32 s64, s64, 15
    s_lshl_b32 s64, s64, 8
    v_subrev_u32 v222, s64, v200
    s_add_u32 s64, s72, 13
    s_and_b32 s64, s64, 15
    s_lshl_b32 s64, s64, 8
    v_subrev_u32 v223, s64, v200
    s_add_u32 s64, s72, 14
    s_and_b32 s64, s64, 15
    s_lshl_b32 s64, s64, 8
    v_subrev_u32 v224, s64, v200
    s_add_u32 s64, s72, 15
    s_and_b32 s64, s64, 15
    s_lshl_b32 s64, s64, 8
    v_subrev_u32 v225, s64, v200
    v_bfe_u32 v203, v1, 1, 3
    v_lshlrev_b32 v203, 4, v203
    v_lshl_add_u32 v203, v202, 2, v203
    s_lshl_b32 s64, s4, 7
    s_and_b32 s65, s68, 2
    s_lshl_b32 s65, s65, 2
    s_add_u32 s64, s64, s65
    s_add_u32 s64, s64, 3145728
    v_add_u32 v236, s64, v203
    v_and_b32 v204, 15, v1
    v_lshrrev_b32 v205, 4, v1
    v_add_u32 v206, 1, v204
    v_and_b32 v207, 1, v206
    v_mul_u32_u24 v207, 4158, v207
    v_lshl_add_u32 v206, v206, 1, v207
    v_lshl_add_u32 v206, v205, 4, v206
    v_lshlrev_b32 v207, 5, v204
    v_sub_u32 v207, 25440, v207
    v_lshl_add_u32 v207, v205, 4, v207
    s_lshr_b32 s64, s68, 1
    s_and_b32 s65, s68, 1
    s_lshl_b32 s65, s65, 8
    s_mul_i32 s66, s64, 8320
    s_add_u32 s66, s66, s65
    v_add_u32 v226, s66, v206
    s_mul_i32 s66, s64, 4608
    s_add_u32 s66, s66, s65
    v_add_u32 v243, s66, v207
    s_lshl_b32 s65, s68, 7
    s_add_u32 s66, s65, 16640
    v_add_u32 v230, s66, v206
    s_and_b32 s66, s51, 1
    s_add_u32 s66, s66, 2
    s_mul_i32 s66, s66, 4608
    s_add_u32 s66, s66, s65
    v_add_u32 v242, s66, v207
    v_add_u32 v227, 1024, v226
    v_add_u32 v231, 1024, v230
    v_add_u32 v228, 2048, v226
    v_add_u32 v232, 2048, v230
    v_add_u32 v229, 3072, v226
    v_add_u32 v233, 3072, v230
    s_lshl_b32 s64, s68, 13
    s_add_u32 s64, s64, 43392
    v_add_u32 v241, s64, v252
    s_lshl_b32 s64, s68, 11
    s_add_u32 s64, s64, 43392
    v_add_u32 v239, s64, v252
    v_add_u32 v240, 32768, v239
    s_lshr_b32 s64, s68, 1
    s_and_b32 s65, s68, 1
    s_lshl_b32 s66, s64, 10
    s_lshl_b32 s67, s65, 3
    s_add_u32 s66, s66, s67
    s_add_u32 s66, s66, 76160
    v_add_u32 v238, s66, v252
    v_lshlrev_b32 v206, 4, v204
    v_lshl_add_u32 v206, v205, 2, v206
    v_mul_u32_u24 v237, 2304, v206
    s_sub_u32 s66, 7, s52
    s_cmp_eq_u32 s64, 0
    s_cselect_b32 s66, s52, s66
    s_mul_i32 s70, s66, 589824
    s_mul_i32 s66, s65, 4608
    s_add_u32 s70, s70, s66
    s_lshl_b32 s66, s51, 1
    s_add_u32 s70, s70, s66
    s_add_u32 s70, s70, 1152
    s_mul_i32 s69, s68, 1179648
    s_lshl_b32 s66, s50, 1
    s_add_u32 s69, s69, s66
    s_add_u32 s69, s69, 1152
    v_lshrrev_b32 v200, 3, v1
    v_and_b32 v201, 7, v1
    v_and_b32 v202, 2, v200
    v_xor_b32 v202, v201, v202
    v_lshlrev_b32 v202, 4, v202
    s_movk_i32 s64, 1152
    v_mad_u32_u24 v244, v200, s64, v202
    v_xor_b32 v245, 64, v244
    v_mul_u32_u24 v203, 9, v200
    v_and_b32 v206, 1, v200
    v_lshlrev_b32 v206, 3, v206
    v_sub_u32 v203, v203, v206
    v_mad_u32_u24 v246, v203, s64, v202
    v_xor_b32 v247, 64, v246
    v_mad_u32_u24 v203, v205, 18, v204
    v_mul_u32_u24 v248, 1152, v203
    v_mul_u32_u24 v203, 9, v201
    v_and_b32 v206, 1, v201
    v_lshlrev_b32 v206, 3, v206
    v_sub_u32 v203, v203, v206
    v_mul_u32_u24 v249, 1152, v203
    s_mul_i32 s73, s68, 165888
    s_add_u32 s73, s73, s81
    s_mul_i32 s74, s68, 2304
    s_lshl_b32 s64, s4, 2
    s_add_u32 s64, s64, s68
    s_mul_i32 s71, s64, 36864
    s_add_u32 s71, s71, s81
    s_mul_i32 s64, s64, 18432
    s_add_u32 s64, s64, 331776
    v_add_u32 v235, s64, v252
    v_mul_u32_u24 v200, 160, v204
    v_lshl_add_u32 v200, v205, 3, v200
    s_mul_i32 s64, s68, 2560
    s_add_u32 s64, s64, 87808
    v_add_u32 v234, s64, v200
    v_add_u32 v200, 0, v1
    v_mul_u32_u24 v201, 7282, v200
    v_lshrrev_b32 v201, 16, v201
    v_add_u32 v202, v200, v201
    v_lshl_add_u32 v190, v202, 4, s64
    v_mul_u32_u24 v201, 135, v201
    v_add_lshl_u32 v193, v200, v201, 4
    v_add_u32 v200, 64, v1
    v_mul_u32_u24 v201, 7282, v200
    v_lshrrev_b32 v201, 16, v201
    v_add_u32 v202, v200, v201
    v_lshl_add_u32 v191, v202, 4, s64
    v_mul_u32_u24 v201, 135, v201
    v_add_lshl_u32 v194, v200, v201, 4
    v_add_u32 v200, 128, v1
    v_mul_u32_u24 v201, 7282, v200
    v_lshrrev_b32 v201, 16, v201
    v_add_u32 v202, v200, v201
    v_lshl_add_u32 v192, v202, 4, s64
    v_mul_u32_u24 v201, 135, v201
    v_add_lshl_u32 v195, v200, v201, 4
    v_bfe_u32 v200, v1, 2, 2
    v_and_b32 v201, 3, v1
    v_lshrrev_b32 v202, 1, v200
    v_and_b32 v203, 1, v205
    v_lshl_or_b32 v202, v203, 1, v202
    v_lshl_add_u32 v200, v205, 3, v200
    v_lshlrev_b32 v203, 7, v200
    v_lshl_add_u32 v203, v201, 3, v203
    v_and_b32 v201, 1, v201
    v_lshlrev_b32 v201, 3, v201
    v_lshl_add_u32 v200, v200, 4, v201
    v_add_u32 v189, 73728, v200
    v_xor_b32 v200, 0, v202
    v_lshl_add_u32 v181, v200, 5, v203
    v_add_u32 v185, 36864, v181
    v_xor_b32 v200, 1, v202
    v_lshl_add_u32 v182, v200, 5, v203
    v_add_u32 v186, 36864, v182
    v_xor_b32 v200, 2, v202
    v_lshl_add_u32 v183, v200, 5, v203
    v_add_u32 v187, 36864, v183
    v_xor_b32 v200, 3, v202
    v_lshl_add_u32 v184, v200, 5, v203
    v_add_u32 v188, 36864, v184
Lspin_21:
    ds_read_b32 v2, v253 offset:96
    s_waitcnt lgkmcnt(0)
    v_cmp_gt_u32 vcc, 1, v2
    s_cbranch_vccnz Lspin_21_s
    ds_write_b128 v6, v[40:43] offset:32
    ds_write_b128 v6, v[44:47] offset:288
    ds_write_b128 v7, v[48:51] offset:2080
    ds_write_b128 v7, v[52:55] offset:3104
    s_mov_b64 exec, 7
    ds_write_b128 v9, v[56:59]
    s_mov_b64 exec, -1
    ds_read_b128 v[64:67], v8 offset:16
    ds_read_b32 v68, v8 offset:32
    ds_read_b128 v[70:73], v8 offset:1040
    ds_read_b32 v74, v8 offset:1056
    ds_read_b128 v[76:79], v8 offset:2064
    ds_read_b32 v80, v8 offset:2080
    ds_read_b128 v[82:85], v8 offset:3088
    ds_read_b32 v86, v8 offset:3104
    ds_read_b128 v[88:91], v8 offset:3104
    ds_read_b32 v92, v8 offset:3120
    s_waitcnt lgkmcnt(8)
    v_alignbit_b32 v64, v65, v64, 16
    v_alignbit_b32 v65, v66, v65, 16
    v_alignbit_b32 v66, v67, v66, 16
    v_alignbit_b32 v67, v68, v67, 16
    ds_write_b128 v8, v[64:67] offset:4176
    s_waitcnt lgkmcnt(7)
    v_alignbit_b32 v70, v71, v70, 16
    v_alignbit_b32 v71, v72, v71, 16
    v_alignbit_b32 v72, v73, v72, 16
    v_alignbit_b32 v73, v74, v73, 16
    ds_write_b128 v8, v[70:73] offset:5200
    s_waitcnt lgkmcnt(6)
    v_alignbit_b32 v76, v77, v76, 16
    v_alignbit_b32 v77, v78, v77, 16
    v_alignbit_b32 v78, v79, v78, 16
    v_alignbit_b32 v79, v80, v79, 16
    ds_write_b128 v8, v[76:79] offset:6224
    s_waitcnt lgkmcnt(5)
    v_alignbit_b32 v82, v83, v82, 16
    v_alignbit_b32 v83, v84, v83, 16
    v_alignbit_b32 v84, v85, v84, 16
    v_alignbit_b32 v85, v86, v85, 16
    ds_write_b128 v8, v[82:85] offset:7248
    s_waitcnt lgkmcnt(4)
    v_alignbit_b32 v88, v89, v88, 16
    v_alignbit_b32 v89, v90, v89, 16
    v_alignbit_b32 v90, v91, v90, 16
    v_alignbit_b32 v91, v92, v91, 16
    ds_write_b128 v8, v[88:91] offset:7264
    ds_read_b32 v2, v253 offset:24
    s_waitcnt lgkmcnt(0)
    v_readfirstlane_b32 s7, v2
Lspin_22:
    ds_read_b32 v2, v253 offset:112
    s_waitcnt lgkmcnt(0)
    v_cmp_gt_u32 vcc, 1, v2
    s_cbranch_vccnz Lspin_22_s
L_ssm:
    s_mov_b32 s8, s26
    s_and_b32 s9, s27, 0xffff
    s_mov_b32 s10, 2359296
    s_mov_b32 s11, 0x20000
    s_add_u32 s56, s72, 0
    s_and_b32 s56, s56, 15
    s_mul_i32 s56, s56, 147456
    buffer_load_dword v128, v251, s[8:11], s56 offen
    s_add_u32 s56, s72, 1
    s_and_b32 s56, s56, 15
    s_mul_i32 s56, s56, 147456
    buffer_load_dword v129, v251, s[8:11], s56 offen
    s_add_u32 s56, s72, 2
    s_and_b32 s56, s56, 15
    s_mul_i32 s56, s56, 147456
    buffer_load_dword v130, v251, s[8:11], s56 offen
    s_add_u32 s56, s72, 3
    s_and_b32 s56, s56, 15
    s_mul_i32 s56, s56, 147456
    buffer_load_dword v131, v251, s[8:11], s56 offen
    s_add_u32 s56, s72, 4
    s_and_b32 s56, s56, 15
    s_mul_i32 s56, s56, 147456
    buffer_load_dword v132, v251, s[8:11], s56 offen
    s_add_u32 s56, s72, 5
    s_and_b32 s56, s56, 15
    s_mul_i32 s56, s56, 147456
    buffer_load_dword v133, v251, s[8:11], s56 offen
    s_add_u32 s56, s72, 6
    s_and_b32 s56, s56, 15
    s_mul_i32 s56, s56, 147456
    buffer_load_dword v134, v251, s[8:11], s56 offen
    s_add_u32 s56, s72, 7
    s_and_b32 s56, s56, 15
    s_mul_i32 s56, s56, 147456
    buffer_load_dword v135, v251, s[8:11], s56 offen
    s_add_u32 s56, s72, 8
    s_and_b32 s56, s56, 15
    s_mul_i32 s56, s56, 147456
    buffer_load_dword v136, v251, s[8:11], s56 offen
    s_add_u32 s56, s72, 9
    s_and_b32 s56, s56, 15
    s_mul_i32 s56, s56, 147456
    buffer_load_dword v137, v251, s[8:11], s56 offen
    s_add_u32 s56, s72, 10
    s_and_b32 s56, s56, 15
    s_mul_i32 s56, s56, 147456
    buffer_load_dword v138, v251, s[8:11], s56 offen
    s_add_u32 s56, s72, 11
    s_and_b32 s56, s56, 15
    s_mul_i32 s56, s56, 147456
    buffer_load_dword v139, v251, s[8:11], s56 offen
    s_add_u32 s56, s72, 12
    s_and_b32 s56, s56, 15
    s_mul_i32 s56, s56, 147456
    buffer_load_dword v140, v251, s[8:11], s56 offen
    s_add_u32 s56, s72, 13
    s_and_b32 s56, s56, 15
    s_mul_i32 s56, s56, 147456
    buffer_load_dword v141, v251, s[8:11], s56 offen
    s_add_u32 s56, s72, 14
    s_and_b32 s56, s56, 15
    s_mul_i32 s56, s56, 147456
    buffer_load_dword v142, v251, s[8:11], s56 offen
    s_add_u32 s56, s72, 15
    s_and_b32 s56, s56, 15
    s_mul_i32 s56, s56, 147456
    buffer_load_dword v143, v251, s[8:11], s56 offen
    s_lshr_b32 s59, s2, 3
    s_mul_i32 s59, s59, 20736
    s_mul_i32 s58, s68, 5120
    s_add_u32 s58, s58, s59
    v_min_u32 v3, 41, v1
    v_lshl_add_u32 v3, v3, 7, s58
    global_load_dword v4, v3, s[24:25]
    global_load_dword v5, v236, s[48:49] sc1
    s_lshl_b32 s58, s4, 2
    s_add_u32 s58, s58, s68
    s_mul_i32 s58, s58, 18432
    s_lshl_b32 s59, s81, 4
    s_add_u32 s58, s58, s59
    s_add_u32 s58, s58, 327680
    v_min_u32 v3, 17, v1
    v_lshl_add_u32 v3, v3, 7, s58
    global_load_dword v6, v3, s[48:49] sc1
    s_mul_i32 s54, s68, 4608
    s_add_u32 s54, s54, 29056
    v_lshl_add_u32 v3, v1, 2, s54
    ds_write2st64_b32 v3, v254, v254 offset0:0 offset1:1
    s_mov_b32 s8, s44
    s_and_b32 s9, s45, 0xffff
    s_mov_b32 s10, 4718592
    s_mov_b32 s11, 0x20000
    s_mov_b32 s12, s24
    s_and_b32 s13, s25, 0xffff
    s_mov_b32 s14, 663552
    s_mov_b32 s15, 0x20000
    s_waitcnt vmcnt(0)
    ds_write_b16 v210, v128
    ds_write_b16_d16_hi v210, v128 offset:4608
    ds_write_b16 v211, v129
    ds_write_b16_d16_hi v211, v129 offset:4608
    ds_write_b16 v212, v130
    ds_write_b16_d16_hi v212, v130 offset:4608
    ds_write_b16 v213, v131
    ds_write_b16_d16_hi v213, v131 offset:4608
    ds_write_b16 v214, v132
    ds_write_b16_d16_hi v214, v132 offset:4608
    ds_write_b16 v215, v133
    ds_write_b16_d16_hi v215, v133 offset:4608
    ds_write_b16 v216, v134
    ds_write_b16_d16_hi v216, v134 offset:4608
    ds_write_b16 v217, v135
    ds_write_b16_d16_hi v217, v135 offset:4608
    ds_write_b16 v218, v136
    ds_write_b16_d16_hi v218, v136 offset:4608
    ds_write_b16 v219, v137
    ds_write_b16_d16_hi v219, v137 offset:4608
    ds_write_b16 v220, v138
    ds_write_b16_d16_hi v220, v138 offset:4608
    ds_write_b16 v221, v139
    ds_write_b16_d16_hi v221, v139 offset:4608
    ds_write_b16 v222, v140
    ds_write_b16_d16_hi v222, v140 offset:4608
    ds_write_b16 v223, v141
    ds_write_b16_d16_hi v223, v141 offset:4608
    ds_write_b16 v224, v142
    ds_write_b16_d16_hi v224, v142 offset:4608
    ds_write_b16 v225, v143
    ds_write_b16_d16_hi v225, v143 offset:4608
    v_mov_b32 v2, 1
    s_mov_b64 exec, 1
    ds_add_u32 v253, v2 offset:12
    s_mov_b64 exec, -1
Lspin_23:
    ds_read_b32 v2, v253 offset:12
    s_waitcnt lgkmcnt(0)
    v_cmp_gt_u32 vcc, 4, v2
    s_cbranch_vccnz Lspin_23_s
    s_cmp_lg_u32 s3, 7
    s_cbranch_scc1 L_s1
Lspin_24:
    ds_read_b32 v2, v250 offset:48
    s_waitcnt lgkmcnt(0)
    v_cmp_gt_u32 vcc, 163692, v2
    s_cbranch_vccnz Lspin_24_s
    s_add_u32 s55, s53, 6
    s_and_b32 s55, s55, 7
    s_mul_i32 s55, s55, 18944
    s_add_u32 s55, s55, 131072
    s_add_u32 s56, s48, s55
    s_addc_u32 s57, s49, 0
    s_mov_b32 m0, 144640
Lch_25:
    s_nop 0
    global_load_lds_dwordx4 v252, s[56:57] offset:0 sc1
    global_load_lds_dwordx4 v252, s[56:57] offset:1024 sc1
    global_load_lds_dwordx4 v252, s[56:57] offset:2048 sc1
    s_add_u32 s56, s56, 3072
    s_addc_u32 s57, s57, 0
    s_add_u32 m0, m0, 3072
    s_cmp_lt_u32 m0, 163072
    s_cbranch_scc1 Lch_25
    s_mov_b32 exec_hi, 0
    global_load_lds_dwordx4 v252, s[56:57] sc1
    s_mov_b32 m0, 163704
    s_mov_b64 exec, 1
    global_load_lds_dword v254, s[82:83]
    s_mov_b64 exec, -1
    s_add_u32 s55, s53, 7
    s_and_b32 s55, s55, 7
    s_mul_i32 s55, s55, 18944
    s_add_u32 s55, s55, 131072
    s_add_u32 s56, s48, s55
    s_addc_u32 s57, s49, 0
    s_mov_b32 m0, 125696
Lch_26:
    s_nop 0
    global_load_lds_dwordx4 v252, s[56:57] offset:0 sc1
    global_load_lds_dwordx4 v252, s[56:57] offset:1024 sc1
    global_load_lds_dwordx4 v252, s[56:57] offset:2048 sc1
    s_add_u32 s56, s56, 3072
    s_addc_u32 s57, s57, 0
    s_add_u32 m0, m0, 3072
    s_cmp_lt_u32 m0, 144128
    s_cbranch_scc1 Lch_26
    s_mov_b32 exec_hi, 0
    global_load_lds_dwordx4 v252, s[56:57] sc1
    s_mov_b32 m0, 163708
    s_mov_b64 exec, 1
    global_load_lds_dword v254, s[82:83]
    s_mov_b64 exec, -1
    s_mov_b32 m0, 163712
    s_mov_b64 exec, 1
    global_load_lds_dword v254, s[82:83]
    s_mov_b64 exec, -1
    s_setprio 1
L_s1:
    ds_read_b128 v[48:51], v243 offset:3584
    ds_read2_b32 v[16:17], v226 offset0:0 offset1:1
    ds_read2_b32 v[18:19], v226 offset0:2 offset1:3
    ds_read_b128 v[52:55], v243 offset:3072
    ds_read2_b32 v[20:21], v226 offset0:128 offset1:129
    ds_read2_b32 v[22:23], v226 offset0:130 offset1:131
    ds_read_b128 v[56:59], v243 offset:2560
    ds_read2_b32 v[24:25], v227 offset0:0 offset1:1
    ds_read2_b32 v[26:27], v227 offset0:2 offset1:3
    ds_read_b128 v[60:63], v243 offset:2048
    ds_read2_b32 v[28:29], v227 offset0:128 offset1:129
    ds_read2_b32 v[30:31], v227 offset0:130 offset1:131
    ds_read_b128 v[64:67], v243 offset:1536
    ds_read2_b32 v[32:33], v228 offset0:0 offset1:1
    ds_read2_b32 v[34:35], v228 offset0:2 offset1:3
    s_waitcnt lgkmcnt(12)
    v_mfma_f32_16x16x32_bf16 v[80:83], v[16:19], v[48:51], 0
    ds_read_b128 v[68:71], v243 offset:1024
    ds_read2_b32 v[36:37], v228 offset0:128 offset1:129
    ds_read2_b32 v[38:39], v228 offset0:130 offset1:131
    s_waitcnt lgkmcnt(12)
    v_mfma_f32_16x16x32_bf16 v[84:87], v[16:19], v[52:55], 0
    v_mfma_f32_16x16x32_bf16 v[84:87], v[20:23], v[48:51], v[84:87]
    v_mfma_f32_16x16x32_bf16 v[88:91], v[20:23], v[52:55], 0
    ds_read_b128 v[72:75], v243 offset:512
    ds_read2_b32 v[40:41], v229 offset0:0 offset1:1
    ds_read2_b32 v[42:43], v229 offset0:2 offset1:3
    s_waitcnt lgkmcnt(12)
    v_mfma_f32_16x16x32_bf16 v[88:91], v[16:19], v[56:59], v[88:91]
    v_mfma_f32_16x16x32_bf16 v[92:95], v[20:23], v[56:59], 0
    v_mfma_f32_16x16x32_bf16 v[88:91], v[24:27], v[48:51], v[88:91]
    v_mfma_f32_16x16x32_bf16 v[92:95], v[24:27], v[52:55], v[92:95]
    v_mfma_f32_16x16x32_bf16 v[96:99], v[24:27], v[56:59], 0
    ds_read_b128 v[76:79], v243 offset:0
    ds_read2_b32 v[44:45], v229 offset0:128 offset1:129
    ds_read2_b32 v[46:47], v229 offset0:130 offset1:131
    s_waitcnt lgkmcnt(12)
    v_mfma_f32_16x16x32_bf16 v[92:95], v[16:19], v[60:63], v[92:95]
    v_mfma_f32_16x16x32_bf16 v[96:99], v[20:23], v[60:63], v[96:99]
    v_mfma_f32_16x16x32_bf16 v[100:103], v[24:27], v[60:63], 0
    v_mfma_f32_16x16x32_bf16 v[92:95], v[28:31], v[48:51], v[92:95]
    v_mfma_f32_16x16x32_bf16 v[96:99], v[28:31], v[52:55], v[96:99]
    v_mfma_f32_16x16x32_bf16 v[100:103], v[28:31], v[56:59], v[100:103]
    v_mfma_f32_16x16x32_bf16 v[104:107], v[28:31], v[60:63], 0
    s_waitcnt lgkmcnt(9)
    v_mfma_f32_16x16x32_bf16 v[96:99], v[16:19], v[64:67], v[96:99]
    v_mfma_f32_16x16x32_bf16 v[100:103], v[20:23], v[64:67], v[100:103]
    v_mfma_f32_16x16x32_bf16 v[104:107], v[24:27], v[64:67], v[104:107]
    v_mfma_f32_16x16x32_bf16 v[108:111], v[28:31], v[64:67], 0
    v_mfma_f32_16x16x32_bf16 v[96:99], v[32:35], v[48:51], v[96:99]
    v_mfma_f32_16x16x32_bf16 v[100:103], v[32:35], v[52:55], v[100:103]
    v_mfma_f32_16x16x32_bf16 v[104:107], v[32:35], v[56:59], v[104:107]
    v_mfma_f32_16x16x32_bf16 v[108:111], v[32:35], v[60:63], v[108:111]
    s_waitcnt lgkmcnt(6)
    v_mfma_f32_16x16x32_bf16 v[100:103], v[16:19], v[68:71], v[100:103]
    v_mfma_f32_16x16x32_bf16 v[104:107], v[20:23], v[68:71], v[104:107]
    v_mfma_f32_16x16x32_bf16 v[108:111], v[24:27], v[68:71], v[108:111]
    v_mfma_f32_16x16x32_bf16 v[100:103], v[36:39], v[48:51], v[100:103]
    v_mfma_f32_16x16x32_bf16 v[104:107], v[36:39], v[52:55], v[104:107]
    v_mfma_f32_16x16x32_bf16 v[108:111], v[36:39], v[56:59], v[108:111]
    s_waitcnt lgkmcnt(3)
    v_mfma_f32_16x16x32_bf16 v[104:107], v[16:19], v[72:75], v[104:107]
    v_mfma_f32_16x16x32_bf16 v[108:111], v[20:23], v[72:75], v[108:111]
    v_mfma_f32_16x16x32_bf16 v[104:107], v[40:43], v[48:51], v[104:107]
    v_mfma_f32_16x16x32_bf16 v[108:111], v[40:43], v[52:55], v[108:111]
    s_waitcnt lgkmcnt(0)
    v_mfma_f32_16x16x32_bf16 v[108:111], v[16:19], v[76:79], v[108:111]
    v_mfma_f32_16x16x32_bf16 v[108:111], v[44:47], v[48:51], v[108:111]
    ds_read_b128 v[48:51], v243 offset:3648
    ds_read2_b32 v[16:17], v226 offset0:16 offset1:17
    ds_read2_b32 v[18:19], v226 offset0:18 offset1:19
    ds_read_b128 v[52:55], v243 offset:3136
    ds_read2_b32 v[20:21], v226 offset0:144 offset1:145
    ds_read2_b32 v[22:23], v226 offset0:146 offset1:147
    ds_read_b128 v[56:59], v243 offset:2624
    ds_read2_b32 v[24:25], v227 offset0:16 offset1:17
    ds_read2_b32 v[26:27], v227 offset0:18 offset1:19
    ds_read_b128 v[60:63], v243 offset:2112
    ds_read2_b32 v[28:29], v227 offset0:144 offset1:145
    ds_read2_b32 v[30:31], v227 offset0:146 offset1:147
    ds_read_b128 v[64:67], v243 offset:1600
    ds_read2_b32 v[32:33], v228 offset0:16 offset1:17
    ds_read2_b32 v[34:35], v228 offset0:18 offset1:19
    s_waitcnt lgkmcnt(12)
    v_mfma_f32_16x16x32_bf16 v[80:83], v[16:19], v[48:51], v[80:83]
    ds_read_b128 v[68:71], v243 offset:1088
    ds_read2_b32 v[36:37], v228 offset0:144 offset1:145
    ds_read2_b32 v[38:39], v228 offset0:146 offset1:147
    s_waitcnt lgkmcnt(12)
    v_mfma_f32_16x16x32_bf16 v[84:87], v[16:19], v[52:55], v[84:87]
    v_mfma_f32_16x16x32_bf16 v[84:87], v[20:23], v[48:51], v[84:87]
    v_mfma_f32_16x16x32_bf16 v[88:91], v[20:23], v[52:55], v[88:91]
    ds_read_b128 v[72:75], v243 offset:576
    ds_read2_b32 v[40:41], v229 offset0:16 offset1:17
    ds_read2_b32 v[42:43], v229 offset0:18 offset1:19
    s_waitcnt lgkmcnt(12)
    v_mfma_f32_16x16x32_bf16 v[88:91], v[16:19], v[56:59], v[88:91]
    v_mfma_f32_16x16x32_bf16 v[92:95], v[20:23], v[56:59], v[92:95]
    v_mfma_f32_16x16x32_bf16 v[88:91], v[24:27], v[48:51], v[88:91]
    v_mfma_f32_16x16x32_bf16 v[92:95], v[24:27], v[52:55], v[92:95]
    v_mfma_f32_16x16x32_bf16 v[96:99], v[24:27], v[56:59], v[96:99]
    ds_read_b128 v[76:79], v243 offset:64
    ds_read2_b32 v[44:45], v229 offset0:144 offset1:145
    ds_read2_b32 v[46:47], v229 offset0:146 offset1:147
    s_waitcnt lgkmcnt(12)
    v_mfma_f32_16x16x32_bf16 v[92:95], v[16:19], v[60:63], v[92:95]
    v_mfma_f32_16x16x32_bf16 v[96:99], v[20:23], v[60:63], v[96:99]
    v_mfma_f32_16x16x32_bf16 v[100:103], v[24:27], v[60:63], v[100:103]
    v_mfma_f32_16x16x32_bf16 v[92:95], v[28:31], v[48:51], v[92:95]
    v_mfma_f32_16x16x32_bf16 v[96:99], v[28:31], v[52:55], v[96:99]
    v_mfma_f32_16x16x32_bf16 v[100:103], v[28:31], v[56:59], v[100:103]
    v_mfma_f32_16x16x32_bf16 v[104:107], v[28:31], v[60:63], v[104:107]
    s_waitcnt lgkmcnt(9)
    v_mfma_f32_16x16x32_bf16 v[96:99], v[16:19], v[64:67], v[96:99]
    v_mfma_f32_16x16x32_bf16 v[100:103], v[20:23], v[64:67], v[100:103]
    v_mfma_f32_16x16x32_bf16 v[104:107], v[24:27], v[64:67], v[104:107]
    v_mfma_f32_16x16x32_bf16 v[108:111], v[28:31], v[64:67], v[108:111]
    v_mfma_f32_16x16x32_bf16 v[96:99], v[32:35], v[48:51], v[96:99]
    v_mfma_f32_16x16x32_bf16 v[100:103], v[32:35], v[52:55], v[100:103]
    v_mfma_f32_16x16x32_bf16 v[104:107], v[32:35], v[56:59], v[104:107]
    v_mfma_f32_16x16x32_bf16 v[108:111], v[32:35], v[60:63], v[108:111]
    s_waitcnt lgkmcnt(6)
    v_mfma_f32_16x16x32_bf16 v[100:103], v[16:19], v[68:71], v[100:103]
    v_mfma_f32_16x16x32_bf16 v[104:107], v[20:23], v[68:71], v[104:107]
    v_mfma_f32_16x16x32_bf16 v[108:111], v[24:27], v[68:71], v[108:111]
    v_mfma_f32_16x16x32_bf16 v[100:103], v[36:39], v[48:51], v[100:103]
    v_mfma_f32_16x16x32_bf16 v[104:107], v[36:39], v[52:55], v[104:107]
    v_mfma_f32_16x16x32_bf16 v[108:111], v[36:39], v[56:59], v[108:111]
    s_waitcnt lgkmcnt(3)
    v_mfma_f32_16x16x32_bf16 v[104:107], v[16:19], v[72:75], v[104:107]
    v_mfma_f32_16x16x32_bf16 v[108:111], v[20:23], v[72:75], v[108:111]
    v_mfma_f32_16x16x32_bf16 v[104:107], v[40:43], v[48:51], v[104:107]
    v_mfma_f32_16x16x32_bf16 v[108:111], v[40:43], v[52:55], v[108:111]
    s_waitcnt lgkmcnt(0)
    v_mfma_f32_16x16x32_bf16 v[108:111], v[16:19], v[76:79], v[108:111]
    v_mfma_f32_16x16x32_bf16 v[108:111], v[44:47], v[48:51], v[108:111]
    ds_read_b128 v[48:51], v243 offset:3712
    ds_read2_b32 v[16:17], v226 offset0:32 offset1:33
    ds_read2_b32 v[18:19], v226 offset0:34 offset1:35
    ds_read_b128 v[52:55], v243 offset:3200
    ds_read2_b32 v[20:21], v226 offset0:160 offset1:161
    ds_read2_b32 v[22:23], v226 offset0:162 offset1:163
    ds_read_b128 v[56:59], v243 offset:2688
    ds_read2_b32 v[24:25], v227 offset0:32 offset1:33
    ds_read2_b32 v[26:27], v227 offset0:34 offset1:35
    ds_read_b128 v[60:63], v243 offset:2176
    ds_read2_b32 v[28:29], v227 offset0:160 offset1:161
    ds_read2_b32 v[30:31], v227 offset0:162 offset1:163
    ds_read_b128 v[64:67], v243 offset:1664
    ds_read2_b32 v[32:33], v228 offset0:32 offset1:33
    ds_read2_b32 v[34:35], v228 offset0:34 offset1:35
    s_waitcnt lgkmcnt(12)
    v_mfma_f32_16x16x32_bf16 v[80:83], v[16:19], v[48:51], v[80:83]
    ds_read_b128 v[68:71], v243 offset:1152
    ds_read2_b32 v[36:37], v228 offset0:160 offset1:161
    ds_read2_b32 v[38:39], v228 offset0:162 offset1:163
    s_waitcnt lgkmcnt(12)
    v_mfma_f32_16x16x32_bf16 v[84:87], v[16:19], v[52:55], v[84:87]
    v_mfma_f32_16x16x32_bf16 v[84:87], v[20:23], v[48:51], v[84:87]
    v_mfma_f32_16x16x32_bf16 v[88:91], v[20:23], v[52:55], v[88:91]
    ds_read_b128 v[72:75], v243 offset:640
    ds_read2_b32 v[40:41], v229 offset0:32 offset1:33
    ds_read2_b32 v[42:43], v229 offset0:34 offset1:35
    s_waitcnt lgkmcnt(12)
    v_mfma_f32_16x16x32_bf16 v[88:91], v[16:19], v[56:59], v[88:91]
    v_mfma_f32_16x16x32_bf16 v[92:95], v[20:23], v[56:59], v[92:95]
    v_mfma_f32_16x16x32_bf16 v[88:91], v[24:27], v[48:51], v[88:91]
    v_mfma_f32_16x16x32_bf16 v[92:95], v[24:27], v[52:55], v[92:95]
    v_mfma_f32_16x16x32_bf16 v[96:99], v[24:27], v[56:59], v[96:99]
    ds_read_b128 v[76:79], v243 offset:128
    ds_read2_b32 v[44:45], v229 offset0:160 offset1:161
    ds_read2_b32 v[46:47], v229 offset0:162 offset1:163
    s_waitcnt lgkmcnt(12)
    v_mfma_f32_16x16x32_bf16 v[92:95], v[16:19], v[60:63], v[92:95]
    v_mfma_f32_16x16x32_bf16 v[96:99], v[20:23], v[60:63], v[96:99]
    v_mfma_f32_16x16x32_bf16 v[100:103], v[24:27], v[60:63], v[100:103]
    v_mfma_f32_16x16x32_bf16 v[92:95], v[28:31], v[48:51], v[92:95]
    v_mfma_f32_16x16x32_bf16 v[96:99], v[28:31], v[52:55], v[96:99]
    v_mfma_f32_16x16x32_bf16 v[100:103], v[28:31], v[56:59], v[100:103]
    v_mfma_f32_16x16x32_bf16 v[104:107], v[28:31], v[60:63], v[104:107]
    s_waitcnt lgkmcnt(9)
    v_mfma_f32_16x16x32_bf16 v[96:99], v[16:19], v[64:67], v[96:99]
    v_mfma_f32_16x16x32_bf16 v[100:103], v[20:23], v[64:67], v[100:103]
    v_mfma_f32_16x16x32_bf16 v[104:107], v[24:27], v[64:67], v[104:107]
    v_mfma_f32_16x16x32_bf16 v[108:111], v[28:31], v[64:67], v[108:111]
    v_mfma_f32_16x16x32_bf16 v[96:99], v[32:35], v[48:51], v[96:99]
    v_mfma_f32_16x16x32_bf16 v[100:103], v[32:35], v[52:55], v[100:103]
    v_mfma_f32_16x16x32_bf16 v[104:107], v[32:35], v[56:59], v[104:107]
    v_mfma_f32_16x16x32_bf16 v[108:111], v[32:35], v[60:63], v[108:111]
    s_waitcnt lgkmcnt(6)
    v_mfma_f32_16x16x32_bf16 v[100:103], v[16:19], v[68:71], v[100:103]
    v_mfma_f32_16x16x32_bf16 v[104:107], v[20:23], v[68:71], v[104:107]
    v_mfma_f32_16x16x32_bf16 v[108:111], v[24:27], v[68:71], v[108:111]
    v_mfma_f32_16x16x32_bf16 v[100:103], v[36:39], v[48:51], v[100:103]
    v_mfma_f32_16x16x32_bf16 v[104:107], v[36:39], v[52:55], v[104:107]
    v_mfma_f32_16x16x32_bf16 v[108:111], v[36:39], v[56:59], v[108:111]
    s_waitcnt lgkmcnt(3)
    v_mfma_f32_16x16x32_bf16 v[104:107], v[16:19], v[72:75], v[104:107]
    v_mfma_f32_16x16x32_bf16 v[108:111], v[20:23], v[72:75], v[108:111]
    v_mfma_f32_16x16x32_bf16 v[104:107], v[40:43], v[48:51], v[104:107]
    v_mfma_f32_16x16x32_bf16 v[108:111], v[40:43], v[52:55], v[108:111]
    s_waitcnt lgkmcnt(0)
    v_mfma_f32_16x16x32_bf16 v[108:111], v[16:19], v[76:79], v[108:111]
    v_mfma_f32_16x16x32_bf16 v[108:111], v[44:47], v[48:51], v[108:111]
    ds_read_b128 v[48:51], v243 offset:3776
    ds_read2_b32 v[16:17], v226 offset0:48 offset1:49
    ds_read2_b32 v[18:19], v226 offset0:50 offset1:51
    ds_read_b128 v[52:55], v243 offset:3264
    ds_read2_b32 v[20:21], v226 offset0:176 offset1:177
    ds_read2_b32 v[22:23], v226 offset0:178 offset1:179
    ds_read_b128 v[56:59], v243 offset:2752
    ds_read2_b32 v[24:25], v227 offset0:48 offset1:49
    ds_read2_b32 v[26:27], v227 offset0:50 offset1:51
    ds_read_b128 v[60:63], v243 offset:2240
    ds_read2_b32 v[28:29], v227 offset0:176 offset1:177
    ds_read2_b32 v[30:31], v227 offset0:178 offset1:179
    ds_read_b128 v[64:67], v243 offset:1728
    ds_read2_b32 v[32:33], v228 offset0:48 offset1:49
    ds_read2_b32 v[34:35], v228 offset0:50 offset1:51
    s_waitcnt lgkmcnt(12)
    v_mfma_f32_16x16x32_bf16 v[80:83], v[16:19], v[48:51], v[80:83]
    ds_read_b128 v[68:71], v243 offset:1216
    ds_read2_b32 v[36:37], v228 offset0:176 offset1:177
    ds_read2_b32 v[38:39], v228 offset0:178 offset1:179
    s_waitcnt lgkmcnt(12)
    v_mfma_f32_16x16x32_bf16 v[84:87], v[16:19], v[52:55], v[84:87]
    v_mfma_f32_16x16x32_bf16 v[84:87], v[20:23], v[48:51], v[84:87]
    v_mfma_f32_16x16x32_bf16 v[88:91], v[20:23], v[52:55], v[88:91]
    ds_read_b128 v[72:75], v243 offset:704
    ds_read2_b32 v[40:41], v229 offset0:48 offset1:49
    ds_read2_b32 v[42:43], v229 offset0:50 offset1:51
    s_waitcnt lgkmcnt(12)
    v_mfma_f32_16x16x32_bf16 v[88:91], v[16:19], v[56:59], v[88:91]
    v_mfma_f32_16x16x32_bf16 v[92:95], v[20:23], v[56:59], v[92:95]
    v_mfma_f32_16x16x32_bf16 v[88:91], v[24:27], v[48:51], v[88:91]
    v_mfma_f32_16x16x32_bf16 v[92:95], v[24:27], v[52:55], v[92:95]
    v_mfma_f32_16x16x32_bf16 v[96:99], v[24:27], v[56:59], v[96:99]
    ds_read_b128 v[76:79], v243 offset:192
    ds_read2_b32 v[44:45], v229 offset0:176 offset1:177
    ds_read2_b32 v[46:47], v229 offset0:178 offset1:179
    s_waitcnt lgkmcnt(12)
    v_mfma_f32_16x16x32_bf16 v[92:95], v[16:19], v[60:63], v[92:95]
    v_mfma_f32_16x16x32_bf16 v[96:99], v[20:23], v[60:63], v[96:99]
    v_mfma_f32_16x16x32_bf16 v[100:103], v[24:27], v[60:63], v[100:103]
    v_mfma_f32_16x16x32_bf16 v[92:95], v[28:31], v[48:51], v[92:95]
    v_mfma_f32_16x16x32_bf16 v[96:99], v[28:31], v[52:55], v[96:99]
    v_mfma_f32_16x16x32_bf16 v[100:103], v[28:31], v[56:59], v[100:103]
    v_mfma_f32_16x16x32_bf16 v[104:107], v[28:31], v[60:63], v[104:107]
    s_waitcnt lgkmcnt(9)
    v_mfma_f32_16x16x32_bf16 v[96:99], v[16:19], v[64:67], v[96:99]
    v_mfma_f32_16x16x32_bf16 v[100:103], v[20:23], v[64:67], v[100:103]
    v_mfma_f32_16x16x32_bf16 v[104:107], v[24:27], v[64:67], v[104:107]
    v_mfma_f32_16x16x32_bf16 v[108:111], v[28:31], v[64:67], v[108:111]
    v_mfma_f32_16x16x32_bf16 v[96:99], v[32:35], v[48:51], v[96:99]
    v_mfma_f32_16x16x32_bf16 v[100:103], v[32:35], v[52:55], v[100:103]
    v_mfma_f32_16x16x32_bf16 v[104:107], v[32:35], v[56:59], v[104:107]
    v_mfma_f32_16x16x32_bf16 v[108:111], v[32:35], v[60:63], v[108:111]
    s_waitcnt lgkmcnt(6)
    v_mfma_f32_16x16x32_bf16 v[100:103], v[16:19], v[68:71], v[100:103]
    v_mfma_f32_16x16x32_bf16 v[104:107], v[20:23], v[68:71], v[104:107]
    v_mfma_f32_16x16x32_bf16 v[108:111], v[24:27], v[68:71], v[108:111]
    v_mfma_f32_16x16x32_bf16 v[100:103], v[36:39], v[48:51], v[100:103]
    v_mfma_f32_16x16x32_bf16 v[104:107], v[36:39], v[52:55], v[104:107]
    v_mfma_f32_16x16x32_bf16 v[108:111], v[36:39], v[56:59], v[108:111]
    s_waitcnt lgkmcnt(3)
    v_mfma_f32_16x16x32_bf16 v[104:107], v[16:19], v[72:75], v[104:107]
    v_mfma_f32_16x16x32_bf16 v[108:111], v[20:23], v[72:75], v[108:111]
    v_mfma_f32_16x16x32_bf16 v[104:107], v[40:43], v[48:51], v[104:107]
    v_mfma_f32_16x16x32_bf16 v[108:111], v[40:43], v[52:55], v[108:111]
    s_waitcnt lgkmcnt(0)
    v_mfma_f32_16x16x32_bf16 v[108:111], v[16:19], v[76:79], v[108:111]
    v_mfma_f32_16x16x32_bf16 v[108:111], v[44:47], v[48:51], v[108:111]
    s_cmp_lg_u32 s52, 0
    s_cbranch_scc1 L_cs1
    ds_read_b128 v[48:51], v242 offset:3584
    ds_read2_b32 v[16:17], v230 offset0:0 offset1:1
    ds_read2_b32 v[18:19], v230 offset0:2 offset1:3
    ds_read_b128 v[52:55], v242 offset:3072
    ds_read2_b32 v[20:21], v230 offset0:128 offset1:129
    ds_read2_b32 v[22:23], v230 offset0:130 offset1:131
    ds_read_b128 v[56:59], v242 offset:2560
    ds_read2_b32 v[24:25], v231 offset0:0 offset1:1
    ds_read2_b32 v[26:27], v231 offset0:2 offset1:3
    ds_read_b128 v[60:63], v242 offset:2048
    ds_read2_b32 v[28:29], v231 offset0:128 offset1:129
    ds_read2_b32 v[30:31], v231 offset0:130 offset1:131
    ds_read_b128 v[64:67], v242 offset:1536
    ds_read2_b32 v[32:33], v232 offset0:0 offset1:1
    ds_read2_b32 v[34:35], v232 offset0:2 offset1:3
    s_waitcnt lgkmcnt(12)
    v_mfma_f32_16x16x32_bf16 v[112:115], v[16:19], v[48:51], 0
    ds_read_b128 v[68:71], v242 offset:1024
    ds_read2_b32 v[36:37], v232 offset0:128 offset1:129
    ds_read2_b32 v[38:39], v232 offset0:130 offset1:131
    ds_read_b128 v[72:75], v242 offset:512
    ds_read2_b32 v[40:41], v233 offset0:0 offset1:1
    ds_read2_b32 v[42:43], v233 offset0:2 offset1:3
    ds_read_b128 v[76:79], v242 offset:0
    ds_read2_b32 v[44:45], v233 offset0:128 offset1:129
    ds_read2_b32 v[46:47], v233 offset0:130 offset1:131
    s_waitcnt lgkmcnt(9)
    v_mfma_f32_16x16x32_bf16 v[116:119], v[28:31], v[64:67], 0
    v_mfma_f32_16x16x32_bf16 v[116:119], v[32:35], v[60:63], v[116:119]
    s_waitcnt lgkmcnt(6)
    v_mfma_f32_16x16x32_bf16 v[116:119], v[24:27], v[68:71], v[116:119]
    v_mfma_f32_16x16x32_bf16 v[116:119], v[36:39], v[56:59], v[116:119]
    s_waitcnt lgkmcnt(3)
    v_mfma_f32_16x16x32_bf16 v[116:119], v[20:23], v[72:75], v[116:119]
    v_mfma_f32_16x16x32_bf16 v[116:119], v[40:43], v[52:55], v[116:119]
    s_waitcnt lgkmcnt(0)
    v_mfma_f32_16x16x32_bf16 v[116:119], v[16:19], v[76:79], v[116:119]
    v_mfma_f32_16x16x32_bf16 v[116:119], v[44:47], v[48:51], v[116:119]
    ds_read_b128 v[48:51], v242 offset:3648
    ds_read2_b32 v[16:17], v230 offset0:16 offset1:17
    ds_read2_b32 v[18:19], v230 offset0:18 offset1:19
    ds_read_b128 v[52:55], v242 offset:3136
    ds_read2_b32 v[20:21], v230 offset0:144 offset1:145
    ds_read2_b32 v[22:23], v230 offset0:146 offset1:147
    ds_read_b128 v[56:59], v242 offset:2624
    ds_read2_b32 v[24:25], v231 offset0:16 offset1:17
    ds_read2_b32 v[26:27], v231 offset0:18 offset1:19
    ds_read_b128 v[60:63], v242 offset:2112
    ds_read2_b32 v[28:29], v231 offset0:144 offset1:145
    ds_read2_b32 v[30:31], v231 offset0:146 offset1:147
    ds_read_b128 v[64:67], v242 offset:1600
    ds_read2_b32 v[32:33], v232 offset0:16 offset1:17
    ds_read2_b32 v[34:35], v232 offset0:18 offset1:19
    s_waitcnt lgkmcnt(12)
    v_mfma_f32_16x16x32_bf16 v[112:115], v[16:19], v[48:51], v[112:115]
    ds_read_b128 v[68:71], v242 offset:1088
    ds_read2_b32 v[36:37], v232 offset0:144 offset1:145
    ds_read2_b32 v[38:39], v232 offset0:146 offset1:147
    ds_read_b128 v[72:75], v242 offset:576
    ds_read2_b32 v[40:41], v233 offset0:16 offset1:17
    ds_read2_b32 v[42:43], v233 offset0:18 offset1:19
    ds_read_b128 v[76:79], v242 offset:64
    ds_read2_b32 v[44:45], v233 offset0:144 offset1:145
    ds_read2_b32 v[46:47], v233 offset0:146 offset1:147
    s_waitcnt lgkmcnt(9)
    v_mfma_f32_16x16x32_bf16 v[116:119], v[28:31], v[64:67], v[116:119]
    v_mfma_f32_16x16x32_bf16 v[116:119], v[32:35], v[60:63], v[116:119]
    s_waitcnt lgkmcnt(6)
    v_mfma_f32_16x16x32_bf16 v[116:119], v[24:27], v[68:71], v[116:119]
    v_mfma_f32_16x16x32_bf16 v[116:119], v[36:39], v[56:59], v[116:119]
    s_waitcnt lgkmcnt(3)
    v_mfma_f32_16x16x32_bf16 v[116:119], v[20:23], v[72:75], v[116:119]
    v_mfma_f32_16x16x32_bf16 v[116:119], v[40:43], v[52:55], v[116:119]
    s_waitcnt lgkmcnt(0)
    v_mfma_f32_16x16x32_bf16 v[116:119], v[16:19], v[76:79], v[116:119]
    v_mfma_f32_16x16x32_bf16 v[116:119], v[44:47], v[48:51], v[116:119]
    s_branch L_csd
L_cs1:
    s_cmp_lg_u32 s52, 1
    s_cbranch_scc1 L_cs2
    ds_read_b128 v[48:51], v242 offset:3584
    ds_read2_b32 v[16:17], v230 offset0:0 offset1:1
    ds_read2_b32 v[18:19], v230 offset0:2 offset1:3
    ds_read_b128 v[52:55], v242 offset:3072
    ds_read2_b32 v[20:21], v230 offset0:128 offset1:129
    ds_read2_b32 v[22:23], v230 offset0:130 offset1:131
    ds_read_b128 v[56:59], v242 offset:2560
    ds_read2_b32 v[24:25], v231 offset0:0 offset1:1
    ds_read2_b32 v[26:27], v231 offset0:2 offset1:3
    ds_read_b128 v[60:63], v242 offset:2048
    ds_read2_b32 v[28:29], v231 offset0:128 offset1:129
    ds_read2_b32 v[30:31], v231 offset0:130 offset1:131
    ds_read_b128 v[64:67], v242 offset:1536
    ds_read2_b32 v[32:33], v232 offset0:0 offset1:1
    ds_read2_b32 v[34:35], v232 offset0:2 offset1:3
    ds_read_b128 v[68:71], v242 offset:1024
    ds_read2_b32 v[36:37], v232 offset0:128 offset1:129
    ds_read2_b32 v[38:39], v232 offset0:130 offset1:131
    s_waitcnt lgkmcnt(12)
    v_mfma_f32_16x16x32_bf16 v[112:115], v[16:19], v[52:55], 0
    v_mfma_f32_16x16x32_bf16 v[112:115], v[20:23], v[48:51], v[112:115]
    ds_read_b128 v[72:75], v242 offset:512
    ds_read2_b32 v[40:41], v233 offset0:0 offset1:1
    ds_read2_b32 v[42:43], v233 offset0:2 offset1:3
    s_waitcnt lgkmcnt(9)
    v_mfma_f32_16x16x32_bf16 v[116:119], v[28:31], v[60:63], 0
    s_waitcnt lgkmcnt(6)
    v_mfma_f32_16x16x32_bf16 v[116:119], v[24:27], v[64:67], v[116:119]
    v_mfma_f32_16x16x32_bf16 v[116:119], v[32:35], v[56:59], v[116:119]
    s_waitcnt lgkmcnt(3)
    v_mfma_f32_16x16x32_bf16 v[116:119], v[20:23], v[68:71], v[116:119]
    v_mfma_f32_16x16x32_bf16 v[116:119], v[36:39], v[52:55], v[116:119]
    s_waitcnt lgkmcnt(0)
    v_mfma_f32_16x16x32_bf16 v[116:119], v[16:19], v[72:75], v[116:119]
    v_mfma_f32_16x16x32_bf16 v[116:119], v[40:43], v[48:51], v[116:119]
    ds_read_b128 v[48:51], v242 offset:3648
    ds_read2_b32 v[16:17], v230 offset0:16 offset1:17
    ds_read2_b32 v[18:19], v230 offset0:18 offset1:19
    ds_read_b128 v[52:55], v242 offset:3136
    ds_read2_b32 v[20:21], v230 offset0:144 offset1:145
    ds_read2_b32 v[22:23], v230 offset0:146 offset1:147
    ds_read_b128 v[56:59], v242 offset:2624
    ds_read2_b32 v[24:25], v231 offset0:16 offset1:17
    ds_read2_b32 v[26:27], v231 offset0:18 offset1:19
    ds_read_b128 v[60:63], v242 offset:2112
    ds_read2_b32 v[28:29], v231 offset0:144 offset1:145
    ds_read2_b32 v[30:31], v231 offset0:146 offset1:147
    ds_read_b128 v[64:67], v242 offset:1600
    ds_read2_b32 v[32:33], v232 offset0:16 offset1:17
    ds_read2_b32 v[34:35], v232 offset0:18 offset1:19
    ds_read_b128 v[68:71], v242 offset:1088
    ds_read2_b32 v[36:37], v232 offset0:144 offset1:145
    ds_read2_b32 v[38:39], v232 offset0:146 offset1:147
    s_waitcnt lgkmcnt(12)
    v_mfma_f32_16x16x32_bf16 v[112:115], v[16:19], v[52:55], v[112:115]
    v_mfma_f32_16x16x32_bf16 v[112:115], v[20:23], v[48:51], v[112:115]
    ds_read_b128 v[72:75], v242 offset:576
    ds_read2_b32 v[40:41], v233 offset0:16 offset1:17
    ds_read2_b32 v[42:43], v233 offset0:18 offset1:19
    s_waitcnt lgkmcnt(9)
    v_mfma_f32_16x16x32_bf16 v[116:119], v[28:31], v[60:63], v[116:119]
    s_waitcnt lgkmcnt(6)
    v_mfma_f32_16x16x32_bf16 v[116:119], v[24:27], v[64:67], v[116:119]
    v_mfma_f32_16x16x32_bf16 v[116:119], v[32:35], v[56:59], v[116:119]
    s_waitcnt lgkmcnt(3)
    v_mfma_f32_16x16x32_bf16 v[116:119], v[20:23], v[68:71], v[116:119]
    v_mfma_f32_16x16x32_bf16 v[116:119], v[36:39], v[52:55], v[116:119]
    s_waitcnt lgkmcnt(0)
    v_mfma_f32_16x16x32_bf16 v[116:119], v[16:19], v[72:75], v[116:119]
    v_mfma_f32_16x16x32_bf16 v[116:119], v[40:43], v[48:51], v[116:119]
    s_branch L_csd
L_cs2:
    s_cmp_lg_u32 s52, 2
    s_cbranch_scc1 L_cs3
    ds_read_b128 v[48:51], v242 offset:3584
    ds_read2_b32 v[16:17], v230 offset0:0 offset1:1
    ds_read2_b32 v[18:19], v230 offset0:2 offset1:3
    ds_read_b128 v[52:55], v242 offset:3072
    ds_read2_b32 v[20:21], v230 offset0:128 offset1:129
    ds_read2_b32 v[22:23], v230 offset0:130 offset1:131
    ds_read_b128 v[56:59], v242 offset:2560
    ds_read2_b32 v[24:25], v231 offset0:0 offset1:1
    ds_read2_b32 v[26:27], v231 offset0:2 offset1:3
    ds_read_b128 v[60:63], v242 offset:2048
    ds_read2_b32 v[28:29], v231 offset0:128 offset1:129
    ds_read2_b32 v[30:31], v231 offset0:130 offset1:131
    ds_read_b128 v[64:67], v242 offset:1536
    ds_read2_b32 v[32:33], v232 offset0:0 offset1:1
    ds_read2_b32 v[34:35], v232 offset0:2 offset1:3
    ds_read_b128 v[68:71], v242 offset:1024
    ds_read2_b32 v[36:37], v232 offset0:128 offset1:129
    ds_read2_b32 v[38:39], v232 offset0:130 offset1:131
    s_waitcnt lgkmcnt(12)
    v_mfma_f32_16x16x32_bf16 v[112:115], v[20:23], v[52:55], 0
    s_waitcnt lgkmcnt(9)
    v_mfma_f32_16x16x32_bf16 v[112:115], v[16:19], v[56:59], v[112:115]
    v_mfma_f32_16x16x32_bf16 v[112:115], v[24:27], v[48:51], v[112:115]
    s_waitcnt lgkmcnt(6)
    v_mfma_f32_16x16x32_bf16 v[116:119], v[24:27], v[60:63], 0
    v_mfma_f32_16x16x32_bf16 v[116:119], v[28:31], v[56:59], v[116:119]
    s_waitcnt lgkmcnt(3)
    v_mfma_f32_16x16x32_bf16 v[116:119], v[20:23], v[64:67], v[116:119]
    v_mfma_f32_16x16x32_bf16 v[116:119], v[32:35], v[52:55], v[116:119]
    s_waitcnt lgkmcnt(0)
    v_mfma_f32_16x16x32_bf16 v[116:119], v[16:19], v[68:71], v[116:119]
    v_mfma_f32_16x16x32_bf16 v[116:119], v[36:39], v[48:51], v[116:119]
    ds_read_b128 v[48:51], v242 offset:3648
    ds_read2_b32 v[16:17], v230 offset0:16 offset1:17
    ds_read2_b32 v[18:19], v230 offset0:18 offset1:19
    ds_read_b128 v[52:55], v242 offset:3136
    ds_read2_b32 v[20:21], v230 offset0:144 offset1:145
    ds_read2_b32 v[22:23], v230 offset0:146 offset1:147
    ds_read_b128 v[56:59], v242 offset:2624
    ds_read2_b32 v[24:25], v231 offset0:16 offset1:17
    ds_read2_b32 v[26:27], v231 offset0:18 offset1:19
    ds_read_b128 v[60:63], v242 offset:2112
    ds_read2_b32 v[28:29], v231 offset0:144 offset1:145
    ds_read2_b32 v[30:31], v231 offset0:146 offset1:147
    ds_read_b128 v[64:67], v242 offset:1600
    ds_read2_b32 v[32:33], v232 offset0:16 offset1:17
    ds_read2_b32 v[34:35], v232 offset0:18 offset1:19
    ds_read_b128 v[68:71], v242 offset:1088
    ds_read2_b32 v[36:37], v232 offset0:144 offset1:145
    ds_read2_b32 v[38:39], v232 offset0:146 offset1:147
    s_waitcnt lgkmcnt(12)
    v_mfma_f32_16x16x32_bf16 v[112:115], v[20:23], v[52:55], v[112:115]
    s_waitcnt lgkmcnt(9)
    v_mfma_f32_16x16x32_bf16 v[112:115], v[16:19], v[56:59], v[112:115]
    v_mfma_f32_16x16x32_bf16 v[112:115], v[24:27], v[48:51], v[112:115]
    s_waitcnt lgkmcnt(6)
    v_mfma_f32_16x16x32_bf16 v[116:119], v[24:27], v[60:63], v[116:119]
    v_mfma_f32_16x16x32_bf16 v[116:119], v[28:31], v[56:59], v[116:119]
    s_waitcnt lgkmcnt(3)
    v_mfma_f32_16x16x32_bf16 v[116:119], v[20:23], v[64:67], v[116:119]
    v_mfma_f32_16x16x32_bf16 v[116:119], v[32:35], v[52:55], v[116:119]
    s_waitcnt lgkmcnt(0)
    v_mfma_f32_16x16x32_bf16 v[116:119], v[16:19], v[68:71], v[116:119]
    v_mfma_f32_16x16x32_bf16 v[116:119], v[36:39], v[48:51], v[116:119]
    s_branch L_csd
L_cs3:
    ds_read_b128 v[48:51], v242 offset:3584
    ds_read2_b32 v[16:17], v230 offset0:0 offset1:1
    ds_read2_b32 v[18:19], v230 offset0:2 offset1:3
    ds_read_b128 v[52:55], v242 offset:3072
    ds_read2_b32 v[20:21], v230 offset0:128 offset1:129
    ds_read2_b32 v[22:23], v230 offset0:130 offset1:131
    ds_read_b128 v[56:59], v242 offset:2560
    ds_read2_b32 v[24:25], v231 offset0:0 offset1:1
    ds_read2_b32 v[26:27], v231 offset0:2 offset1:3
    ds_read_b128 v[60:63], v242 offset:2048
    ds_read2_b32 v[28:29], v231 offset0:128 offset1:129
    ds_read2_b32 v[30:31], v231 offset0:130 offset1:131
    ds_read_b128 v[64:67], v242 offset:1536
    ds_read2_b32 v[32:33], v232 offset0:0 offset1:1
    ds_read2_b32 v[34:35], v232 offset0:2 offset1:3
    s_waitcnt lgkmcnt(6)
    v_mfma_f32_16x16x32_bf16 v[116:119], v[24:27], v[56:59], 0
    v_mfma_f32_16x16x32_bf16 v[112:115], v[20:23], v[56:59], 0
    v_mfma_f32_16x16x32_bf16 v[112:115], v[24:27], v[52:55], v[112:115]
    s_waitcnt lgkmcnt(3)
    v_mfma_f32_16x16x32_bf16 v[116:119], v[20:23], v[60:63], v[116:119]
    v_mfma_f32_16x16x32_bf16 v[116:119], v[28:31], v[52:55], v[116:119]
    v_mfma_f32_16x16x32_bf16 v[112:115], v[16:19], v[60:63], v[112:115]
    v_mfma_f32_16x16x32_bf16 v[112:115], v[28:31], v[48:51], v[112:115]
    s_waitcnt lgkmcnt(0)
    v_mfma_f32_16x16x32_bf16 v[116:119], v[16:19], v[64:67], v[116:119]
    v_mfma_f32_16x16x32_bf16 v[116:119], v[32:35], v[48:51], v[116:119]
    ds_read_b128 v[48:51], v242 offset:3648
    ds_read2_b32 v[16:17], v230 offset0:16 offset1:17
    ds_read2_b32 v[18:19], v230 offset0:18 offset1:19
    ds_read_b128 v[52:55], v242 offset:3136
    ds_read2_b32 v[20:21], v230 offset0:144 offset1:145
    ds_read2_b32 v[22:23], v230 offset0:146 offset1:147
    ds_read_b128 v[56:59], v242 offset:2624
    ds_read2_b32 v[24:25], v231 offset0:16 offset1:17
    ds_read2_b32 v[26:27], v231 offset0:18 offset1:19
    ds_read_b128 v[60:63], v242 offset:2112
    ds_read2_b32 v[28:29], v231 offset0:144 offset1:145
    ds_read2_b32 v[30:31], v231 offset0:146 offset1:147
    ds_read_b128 v[64:67], v242 offset:1600
    ds_read2_b32 v[32:33], v232 offset0:16 offset1:17
    ds_read2_b32 v[34:35], v232 offset0:18 offset1:19
    s_waitcnt lgkmcnt(6)
    v_mfma_f32_16x16x32_bf16 v[116:119], v[24:27], v[56:59], v[116:119]
    v_mfma_f32_16x16x32_bf16 v[112:115], v[20:23], v[56:59], v[112:115]
    v_mfma_f32_16x16x32_bf16 v[112:115], v[24:27], v[52:55], v[112:115]
    s_waitcnt lgkmcnt(3)
    v_mfma_f32_16x16x32_bf16 v[116:119], v[20:23], v[60:63], v[116:119]
    v_mfma_f32_16x16x32_bf16 v[116:119], v[28:31], v[52:55], v[116:119]
    v_mfma_f32_16x16x32_bf16 v[112:115], v[16:19], v[60:63], v[112:115]
    v_mfma_f32_16x16x32_bf16 v[112:115], v[28:31], v[48:51], v[112:115]
    s_waitcnt lgkmcnt(0)
    v_mfma_f32_16x16x32_bf16 v[116:119], v[16:19], v[64:67], v[116:119]
    v_mfma_f32_16x16x32_bf16 v[116:119], v[32:35], v[48:51], v[116:119]
L_csd:
Lspin_27:
    ds_read_b32 v2, v250 offset:48
    s_waitcnt lgkmcnt(0)
    v_cmp_gt_u32 vcc, 163700, v2
    s_cbranch_vccnz Lspin_27_s
    ds_write_b128 v241, v[80:83] offset:0
    ds_write_b128 v241, v[84:87] offset:1024
    ds_write_b128 v241, v[88:91] offset:2048
    ds_write_b128 v241, v[92:95] offset:3072
    ds_write_b128 v241, v[96:99] offset:4096
    ds_write_b128 v241, v[100:103] offset:5120
    ds_write_b128 v241, v[104:107] offset:6144
    ds_write_b128 v241, v[108:111] offset:7168
    ds_write_b128 v240, v[112:115] offset:0
    ds_write_b128 v240, v[116:119] offset:1024
    v_mov_b32 v2, 1
    s_mov_b64 exec, 1
    ds_add_u32 v253, v2 offset:20
    s_mov_b64 exec, -1
Lspin_28:
    ds_read_b32 v3, v253 offset:20
    s_waitcnt lgkmcnt(0)
    v_cmp_gt_u32 vcc, 4, v3
    s_cbranch_vccnz Lspin_28_s
    ds_read_b128 v[16:19], v239 offset:0
    ds_read_b128 v[20:23], v239 offset:8192
    ds_read_b128 v[24:27], v239 offset:16384
    ds_read_b128 v[28:31], v239 offset:24576
    ds_read_b128 v[32:35], v239 offset:1024
    ds_read_b128 v[36:39], v239 offset:9216
    ds_read_b128 v[40:43], v239 offset:17408
    ds_read_b128 v[44:47], v239 offset:25600
    ds_read_b64 v[56:57], v238 offset:0
    ds_read_b64 v[58:59], v238 offset:2048
    ds_read_b64 v[60:61], v238 offset:4096
    ds_read_b64 v[62:63], v238 offset:6144
    s_mov_b64 exec, 1
    ds_add_u32 v253, v2 offset:16
    s_mov_b64 exec, -1
    s_waitcnt lgkmcnt(0)
    v_pk_add_f32 v[16:17], v[16:17], v[20:21]
    v_pk_add_f32 v[18:19], v[18:19], v[22:23]
    v_pk_add_f32 v[24:25], v[24:25], v[28:29]
    v_pk_add_f32 v[26:27], v[26:27], v[30:31]
    v_cvt_pk_bf16_f32 v196, v16, v24
    v_cvt_pk_bf16_f32 v197, v17, v25
    v_cvt_pk_bf16_f32 v198, v18, v26
    v_cvt_pk_bf16_f32 v199, v19, v27
    v_pk_add_f32 v[32:33], v[32:33], v[36:37]
    v_pk_add_f32 v[34:35], v[34:35], v[38:39]
    v_pk_add_f32 v[40:41], v[40:41], v[44:45]
    v_pk_add_f32 v[42:43], v[42:43], v[46:47]
    v_cvt_pk_bf16_f32 v200, v32, v40
    v_cvt_pk_bf16_f32 v201, v33, v41
    v_cvt_pk_bf16_f32 v202, v34, v42
    v_cvt_pk_bf16_f32 v203, v35, v43
    v_pk_add_f32 v[56:57], v[56:57], v[58:59]
    v_pk_add_f32 v[60:61], v[60:61], v[62:63]
    v_pk_add_f32 v[56:57], v[56:57], v[60:61]
    v_cvt_pk_bf16_f32 v204, v56, v57
Lspin_29:
    ds_read_b32 v3, v253 offset:16
    s_waitcnt lgkmcnt(0)
    v_cmp_gt_u32 vcc, 4, v3
    s_cbranch_vccnz Lspin_29_s
    s_lshl_b32 s57, s74, 3
    s_add_u32 m0, s57, 0
    s_add_u32 s59, s73, 0
    buffer_load_dwordx4 v244, s[12:15], s59 offen lds
    s_add_u32 m0, s57, 1024
    s_add_u32 s59, s73, 9216
    buffer_load_dwordx4 v245, s[12:15], s59 offen lds
    s_add_u32 m0, s57, 2048
    s_add_u32 s59, s73, 20736
    buffer_load_dwordx4 v244, s[12:15], s59 offen lds
    s_add_u32 m0, s57, 3072
    s_add_u32 s59, s73, 29952
    buffer_load_dwordx4 v245, s[12:15], s59 offen lds
    s_add_u32 m0, s57, 4096
    s_add_u32 s59, s73, 41472
    buffer_load_dwordx4 v244, s[12:15], s59 offen lds
    s_add_u32 m0, s74, 73728
    s_add_u32 s59, s73, 128
    buffer_load_dwordx4 v248, s[12:15], s59 offen lds
    s_add_u32 m0, s57, 5120
    s_add_u32 s59, s73, 50688
    buffer_load_dwordx4 v245, s[12:15], s59 offen lds
    s_add_u32 m0, s57, 6144
    s_add_u32 s59, s73, 62208
    buffer_load_dwordx4 v244, s[12:15], s59 offen lds
    s_add_u32 m0, s57, 7168
    s_add_u32 s59, s73, 71424
    buffer_load_dwordx4 v245, s[12:15], s59 offen lds
    s_add_u32 m0, s57, 8192
    s_add_u32 s59, s73, 18432
    buffer_load_dwordx4 v246, s[12:15], s59 offen lds
    s_add_u32 m0, s74, 74752
    s_add_u32 s59, s59, 128
    s_mov_b64 exec, 0xff
    buffer_load_dwordx4 v249, s[12:15], s59 offen lds
    s_mov_b64 exec, -1
    s_add_u32 m0, s57, 9216
    s_add_u32 s59, s73, 82944
    buffer_load_dwordx4 v245, s[12:15], s59 offen lds
    s_add_u32 m0, s57, 10240
    s_add_u32 s59, s73, 92160
    buffer_load_dwordx4 v244, s[12:15], s59 offen lds
    s_add_u32 m0, s57, 11264
    s_add_u32 s59, s73, 103680
    buffer_load_dwordx4 v245, s[12:15], s59 offen lds
    s_add_u32 m0, s57, 12288
    s_add_u32 s59, s73, 112896
    buffer_load_dwordx4 v244, s[12:15], s59 offen lds
    s_add_u32 m0, s57, 13312
    s_add_u32 s59, s73, 124416
    buffer_load_dwordx4 v245, s[12:15], s59 offen lds
    s_add_u32 m0, s74, 74880
    s_add_u32 s59, s73, 83072
    buffer_load_dwordx4 v248, s[12:15], s59 offen lds
    s_add_u32 m0, s57, 14336
    s_add_u32 s59, s73, 133632
    buffer_load_dwordx4 v244, s[12:15], s59 offen lds
    s_add_u32 m0, s57, 15360
    s_add_u32 s59, s73, 145152
    buffer_load_dwordx4 v245, s[12:15], s59 offen lds
    s_add_u32 m0, s57, 16384
    s_add_u32 s59, s73, 154368
    buffer_load_dwordx4 v244, s[12:15], s59 offen lds
    s_add_u32 m0, s57, 17408
    s_add_u32 s59, s73, 101376
    buffer_load_dwordx4 v247, s[12:15], s59 offen lds
    s_add_u32 m0, s74, 75904
    s_add_u32 s59, s59, 128
    s_mov_b64 exec, 0xff
    buffer_load_dwordx4 v249, s[12:15], s59 offen lds
    s_mov_b64 exec, -1
    s_lshl_b32 s54, s68, 2
    s_add_u32 m0, s54, 163664
    s_mov_b64 exec, 1
    global_load_lds_dword v254, s[82:83]
    s_mov_b64 exec, -1
Lspin_30:
    ds_read_b32 v2, v250 offset:80
    s_waitcnt lgkmcnt(0)
    v_cmp_gt_u32 vcc, 1, v2
    s_cbranch_vccnz Lspin_30_s
    s_add_u32 s56, s69, 0
    buffer_store_dword v196, v237, s[8:11], s56 offen
    s_add_u32 s56, s69, 2304
    buffer_store_dword v197, v237, s[8:11], s56 offen
    s_add_u32 s56, s69, 4608
    buffer_store_dword v198, v237, s[8:11], s56 offen
    s_add_u32 s56, s69, 6912
    buffer_store_dword v199, v237, s[8:11], s56 offen
    s_add_u32 s56, s69, 589824
    buffer_store_dword v200, v237, s[8:11], s56 offen
    s_add_u32 s56, s69, 592128
    buffer_store_dword v201, v237, s[8:11], s56 offen
    s_add_u32 s56, s69, 594432
    buffer_store_dword v202, v237, s[8:11], s56 offen
    s_add_u32 s56, s69, 596736
    buffer_store_dword v203, v237, s[8:11], s56 offen
    buffer_store_short v204, v237, s[8:11], s70 offen
    buffer_store_short_d16_hi v204, v237, s[8:11], s70 offen offset:2304
Lspin_31:
    ds_read_b32 v2, v250 offset:48
    s_waitcnt lgkmcnt(0)
    v_cmp_gt_u32 vcc, 163716, v2
    s_cbranch_vccnz Lspin_31_s
    ds_read_b64_tr_b16 v[36:37], v181 offset:0
    ds_read_b64_tr_b16 v[38:39], v181 offset:512
    ds_read_b64_tr_b16 v[40:41], v182 offset:0
    ds_read_b64_tr_b16 v[42:43], v182 offset:512
    ds_read_b64_tr_b16 v[44:45], v183 offset:0
    ds_read_b64_tr_b16 v[46:47], v183 offset:512
    ds_read_b64_tr_b16 v[48:49], v184 offset:0
    ds_read_b64_tr_b16 v[50:51], v184 offset:512
    ds_read_b64_tr_b16 v[52:53], v189 offset:0
    ds_read_b64_tr_b16 v[54:55], v189 offset:64
    ds_read_b64_tr_b16 v[56:57], v181 offset:4096
    ds_read_b64_tr_b16 v[58:59], v181 offset:4608
    ds_read_b64_tr_b16 v[60:61], v182 offset:4096
    ds_read_b64_tr_b16 v[62:63], v182 offset:4608
    ds_read_b64_tr_b16 v[64:65], v183 offset:4096
    ds_read_b64_tr_b16 v[66:67], v183 offset:4608
    ds_read_b64_tr_b16 v[68:69], v184 offset:4096
    ds_read_b64_tr_b16 v[70:71], v184 offset:4608
    ds_read_b64_tr_b16 v[72:73], v189 offset:512
    ds_read_b64_tr_b16 v[74:75], v189 offset:576
    ds_read_b64_tr_b16 v[76:77], v181 offset:8192
    ds_read_b64_tr_b16 v[78:79], v181 offset:8704
    ds_read_b64_tr_b16 v[80:81], v182 offset:8192
    ds_read_b64_tr_b16 v[82:83], v182 offset:8704
    ds_read_b64_tr_b16 v[84:85], v183 offset:8192
    ds_read_b64_tr_b16 v[86:87], v183 offset:8704
    ds_read_b64_tr_b16 v[88:89], v184 offset:8192
    ds_read_b64_tr_b16 v[90:91], v184 offset:8704
    ds_read_b64_tr_b16 v[92:93], v189 offset:1024
    ds_read_b64_tr_b16 v[94:95], v189 offset:1088
    ds_read_b64_tr_b16 v[96:97], v181 offset:12288
    ds_read_b64_tr_b16 v[98:99], v181 offset:12800
    ds_read_b64_tr_b16 v[100:101], v182 offset:12288
    ds_read_b64_tr_b16 v[102:103], v182 offset:12800
    ds_read_b64_tr_b16 v[104:105], v183 offset:12288
    ds_read_b64_tr_b16 v[106:107], v183 offset:12800
    ds_read_b64_tr_b16 v[108:109], v184 offset:12288
    ds_read_b64_tr_b16 v[110:111], v184 offset:12800
    ds_read_b64_tr_b16 v[112:113], v189 offset:1536
    ds_read_b64_tr_b16 v[114:115], v189 offset:1600
    ds_read_b64_tr_b16 v[116:117], v181 offset:16384
    ds_read_b64_tr_b16 v[118:119], v181 offset:16896
    ds_read_b64_tr_b16 v[120:121], v182 offset:16384
    ds_read_b64_tr_b16 v[122:123], v182 offset:16896
    ds_read_b64_tr_b16 v[124:125], v183 offset:16384
    ds_read_b64_tr_b16 v[126:127], v183 offset:16896
    ds_read_b64_tr_b16 v[128:129], v184 offset:16384
    ds_read_b64_tr_b16 v[130:131], v184 offset:16896
    ds_read_b64_tr_b16 v[132:133], v189 offset:2048
    ds_read_b64_tr_b16 v[134:135], v189 offset:2112
    ds_read_b64_tr_b16 v[136:137], v181 offset:20480
    ds_read_b64_tr_b16 v[138:139], v181 offset:20992
    ds_read_b64_tr_b16 v[140:141], v182 offset:20480
    ds_read_b64_tr_b16 v[142:143], v182 offset:20992
    ds_read_b64_tr_b16 v[144:145], v183 offset:20480
    ds_read_b64_tr_b16 v[146:147], v183 offset:20992
    ds_read_b64_tr_b16 v[148:149], v184 offset:20480
    ds_read_b64_tr_b16 v[150:151], v184 offset:20992
    ds_read_b64_tr_b16 v[152:153], v189 offset:2560
    ds_read_b64_tr_b16 v[154:155], v189 offset:2624
    ds_read_b64_tr_b16 v[156:157], v181 offset:24576
    ds_read_b64_tr_b16 v[158:159], v181 offset:25088
    ds_read_b64_tr_b16 v[160:161], v182 offset:24576
    ds_read_b64_tr_b16 v[162:163], v182 offset:25088
    ds_read_b64_tr_b16 v[164:165], v183 offset:24576
    ds_read_b64_tr_b16 v[166:167], v183 offset:25088
    ds_read_b64_tr_b16 v[168:169], v184 offset:24576
    ds_read_b64_tr_b16 v[170:171], v184 offset:25088
    ds_read_b64_tr_b16 v[172:173], v189 offset:3072
    ds_read_b64_tr_b16 v[174:175], v189 offset:3136
    ds_read_b64_tr_b16 v[176:177], v181 offset:28672
    ds_read_b64_tr_b16 v[178:179], v181 offset:29184
Lspin_32:
    ds_read_b32 v2, v250 offset:48
    s_waitcnt lgkmcnt(0)
    v_cmp_gt_u32 vcc, 163720, v2
    s_cbranch_vccnz Lspin_32_s
    s_mov_b32 s54, 0
L_pollo:
    global_load_dword v2, v236, s[48:49] sc1
    s_add_u32 s54, s54, 1
    s_waitcnt vmcnt(0)
    v_cmp_ne_u32 vcc, s7, v2
    s_cmp_gt_u32 s54, 1048576
    s_cbranch_scc1 L_pollo_d
    s_cbranch_vccnz L_pollo_s
L_pollo_d:
    global_load_dwordx4 v[4:7], v235, s[48:49] offset:-4096 sc1
    global_load_dwordx4 v[8:11], v235, s[48:49] offset:-3072 sc1
    global_load_dwordx4 v[12:15], v235, s[48:49] offset:-2048 sc1
    global_load_dwordx4 v[16:19], v235, s[48:49] offset:-1024 sc1
    global_load_dwordx4 v[20:23], v235, s[48:49] offset:0 sc1
    global_load_dwordx4 v[24:27], v235, s[48:49] offset:1024 sc1
    global_load_dwordx4 v[28:31], v235, s[48:49] offset:2048 sc1
    global_load_dwordx4 v[32:35], v235, s[48:49] offset:3072 sc1
    s_waitcnt vmcnt(7)
    v_mfma_f32_16x16x32_bf16 v[206:209], v[36:39], v[4:7], 0
    v_mfma_f32_16x16x32_bf16 v[210:213], v[40:43], v[4:7], 0
    ds_read_b64_tr_b16 v[36:37], v182 offset:28672
    ds_read_b64_tr_b16 v[38:39], v182 offset:29184
    v_mfma_f32_16x16x32_bf16 v[214:217], v[44:47], v[4:7], 0
    ds_read_b64_tr_b16 v[40:41], v183 offset:28672
    ds_read_b64_tr_b16 v[42:43], v183 offset:29184
    v_mfma_f32_16x16x32_bf16 v[218:221], v[48:51], v[4:7], 0
    ds_read_b64_tr_b16 v[44:45], v184 offset:28672
    ds_read_b64_tr_b16 v[46:47], v184 offset:29184
    v_mfma_f32_16x16x32_bf16 v[222:225], v[52:55], v[4:7], 0
    ds_read_b64_tr_b16 v[48:49], v189 offset:3584
    s_waitcnt vmcnt(6)
    v_mfma_f32_16x16x32_bf16 v[206:209], v[56:59], v[8:11], v[206:209]
    v_add_u32 v235, 8192, v235
    global_load_dwordx4 v[4:7], v235, s[48:49] offset:-4096 sc1
    v_mfma_f32_16x16x32_bf16 v[210:213], v[60:63], v[8:11], v[210:213]
    ds_read_b64_tr_b16 v[50:51], v189 offset:3648
    ds_read_b64_tr_b16 v[52:53], v181 offset:32768
    ds_read_b64_tr_b16 v[54:55], v181 offset:33280
    v_mfma_f32_16x16x32_bf16 v[214:217], v[64:67], v[8:11], v[214:217]
    ds_read_b64_tr_b16 v[56:57], v182 offset:32768
    ds_read_b64_tr_b16 v[58:59], v182 offset:33280
    v_mfma_f32_16x16x32_bf16 v[218:221], v[68:71], v[8:11], v[218:221]
    ds_read_b64_tr_b16 v[60:61], v183 offset:32768
    v_mfma_f32_16x16x32_bf16 v[222:225], v[72:75], v[8:11], v[222:225]
    ds_read_b64_tr_b16 v[62:63], v183 offset:33280
    ds_read_b64_tr_b16 v[64:65], v184 offset:32768
    s_waitcnt vmcnt(6)
    v_mfma_f32_16x16x32_bf16 v[206:209], v[76:79], v[12:15], v[206:209]
    global_load_dwordx4 v[8:11], v235, s[48:49] offset:-3072 sc1
    v_mfma_f32_16x16x32_bf16 v[210:213], v[80:83], v[12:15], v[210:213]
    ds_read_b64_tr_b16 v[66:67], v184 offset:33280
    ds_read_b64_tr_b16 v[68:69], v189 offset:4096
    ds_read_b64_tr_b16 v[70:71], v189 offset:4160
    v_mfma_f32_16x16x32_bf16 v[214:217], v[84:87], v[12:15], v[214:217]
    ds_read_b64_tr_b16 v[72:73], v185 offset:0
    v_mfma_f32_16x16x32_bf16 v[218:221], v[88:91], v[12:15], v[218:221]
    ds_read_b64_tr_b16 v[74:75], v185 offset:512
    ds_read_b64_tr_b16 v[76:77], v186 offset:0
    v_mfma_f32_16x16x32_bf16 v[222:225], v[92:95], v[12:15], v[222:225]
    ds_read_b64_tr_b16 v[78:79], v186 offset:512
    s_waitcnt vmcnt(6)
    v_mfma_f32_16x16x32_bf16 v[206:209], v[96:99], v[16:19], v[206:209]
    global_load_dwordx4 v[12:15], v235, s[48:49] offset:-2048 sc1
    v_mfma_f32_16x16x32_bf16 v[210:213], v[100:103], v[16:19], v[210:213]
    ds_read_b64_tr_b16 v[80:81], v187 offset:0
    ds_read_b64_tr_b16 v[82:83], v187 offset:512
    ds_read_b64_tr_b16 v[84:85], v188 offset:0
    v_mfma_f32_16x16x32_bf16 v[214:217], v[104:107], v[16:19], v[214:217]
    ds_read_b64_tr_b16 v[86:87], v188 offset:512
    ds_read_b64_tr_b16 v[88:89], v189 offset:4608
    v_mfma_f32_16x16x32_bf16 v[218:221], v[108:111], v[16:19], v[218:221]
    ds_read_b64_tr_b16 v[90:91], v189 offset:4672
    v_mfma_f32_16x16x32_bf16 v[222:225], v[112:115], v[16:19], v[222:225]
    ds_read_b64_tr_b16 v[92:93], v185 offset:4096
    ds_read_b64_tr_b16 v[94:95], v185 offset:4608
    s_waitcnt vmcnt(6)
    v_mfma_f32_16x16x32_bf16 v[206:209], v[116:119], v[20:23], v[206:209]
    global_load_dwordx4 v[16:19], v235, s[48:49] offset:-1024 sc1
    v_mfma_f32_16x16x32_bf16 v[210:213], v[120:123], v[20:23], v[210:213]
    ds_read_b64_tr_b16 v[96:97], v186 offset:4096
    ds_read_b64_tr_b16 v[98:99], v186 offset:4608
    ds_read_b64_tr_b16 v[100:101], v187 offset:4096
    v_mfma_f32_16x16x32_bf16 v[214:217], v[124:127], v[20:23], v[214:217]
    ds_read_b64_tr_b16 v[102:103], v187 offset:4608
    v_mfma_f32_16x16x32_bf16 v[218:221], v[128:131], v[20:23], v[218:221]
    ds_read_b64_tr_b16 v[104:105], v188 offset:4096
    ds_read_b64_tr_b16 v[106:107], v188 offset:4608
    v_mfma_f32_16x16x32_bf16 v[222:225], v[132:135], v[20:23], v[222:225]
    ds_read_b64_tr_b16 v[108:109], v189 offset:5120
    s_waitcnt vmcnt(6)
    v_mfma_f32_16x16x32_bf16 v[206:209], v[136:139], v[24:27], v[206:209]
    global_load_dwordx4 v[20:23], v235, s[48:49] offset:0 sc1
    v_mfma_f32_16x16x32_bf16 v[210:213], v[140:143], v[24:27], v[210:213]
    ds_read_b64_tr_b16 v[110:111], v189 offset:5184
    ds_read_b64_tr_b16 v[112:113], v185 offset:8192
    ds_read_b64_tr_b16 v[114:115], v185 offset:8704
    v_mfma_f32_16x16x32_bf16 v[214:217], v[144:147], v[24:27], v[214:217]
    ds_read_b64_tr_b16 v[116:117], v186 offset:8192
    ds_read_b64_tr_b16 v[118:119], v186 offset:8704
    v_mfma_f32_16x16x32_bf16 v[218:221], v[148:151], v[24:27], v[218:221]
    ds_read_b64_tr_b16 v[120:121], v187 offset:8192
    v_mfma_f32_16x16x32_bf16 v[222:225], v[152:155], v[24:27], v[222:225]
    ds_read_b64_tr_b16 v[122:123], v187 offset:8704
    ds_read_b64_tr_b16 v[124:125], v188 offset:8192
    s_waitcnt vmcnt(6)
    v_mfma_f32_16x16x32_bf16 v[206:209], v[156:159], v[28:31], v[206:209]
    global_load_dwordx4 v[24:27], v235, s[48:49] offset:1024 sc1
    v_mfma_f32_16x16x32_bf16 v[210:213], v[160:163], v[28:31], v[210:213]
    ds_read_b64_tr_b16 v[126:127], v188 offset:8704
    ds_read_b64_tr_b16 v[128:129], v189 offset:5632
    ds_read_b64_tr_b16 v[130:131], v189 offset:5696
    v_mfma_f32_16x16x32_bf16 v[214:217], v[164:167], v[28:31], v[214:217]
    ds_read_b64_tr_b16 v[132:133], v185 offset:12288
    v_mfma_f32_16x16x32_bf16 v[218:221], v[168:171], v[28:31], v[218:221]
    ds_read_b64_tr_b16 v[134:135], v185 offset:12800
    ds_read_b64_tr_b16 v[136:137], v186 offset:12288
    v_mfma_f32_16x16x32_bf16 v[222:225], v[172:175], v[28:31], v[222:225]
    ds_read_b64_tr_b16 v[138:139], v186 offset:12800
    s_waitcnt vmcnt(6)
    v_mfma_f32_16x16x32_bf16 v[206:209], v[176:179], v[32:35], v[206:209]
    global_load_dwordx4 v[28:31], v235, s[48:49] offset:2048 sc1
    s_waitcnt lgkmcnt(15)
    v_mfma_f32_16x16x32_bf16 v[210:213], v[36:39], v[32:35], v[210:213]
    ds_read_b64_tr_b16 v[140:141], v187 offset:12288
    ds_read_b64_tr_b16 v[142:143], v187 offset:12800
    ds_read_b64_tr_b16 v[144:145], v188 offset:12288
    v_mfma_f32_16x16x32_bf16 v[214:217], v[40:43], v[32:35], v[214:217]
    ds_read_b64_tr_b16 v[146:147], v188 offset:12800
    ds_read_b64_tr_b16 v[148:149], v189 offset:6144
    v_mfma_f32_16x16x32_bf16 v[218:221], v[44:47], v[32:35], v[218:221]
    ds_read_b64_tr_b16 v[150:151], v189 offset:6208
    s_waitcnt lgkmcnt(15)
    v_mfma_f32_16x16x32_bf16 v[222:225], v[48:51], v[32:35], v[222:225]
    ds_read_b64_tr_b16 v[152:153], v185 offset:16384
    ds_read_b64_tr_b16 v[154:155], v185 offset:16896
    s_waitcnt vmcnt(6)
    v_mfma_f32_16x16x32_bf16 v[206:209], v[52:55], v[4:7], v[206:209]
    global_load_dwordx4 v[32:35], v235, s[48:49] offset:3072 sc1
    v_mfma_f32_16x16x32_bf16 v[210:213], v[56:59], v[4:7], v[210:213]
    ds_read_b64_tr_b16 v[156:157], v186 offset:16384
    ds_read_b64_tr_b16 v[158:159], v186 offset:16896
    ds_read_b64_tr_b16 v[160:161], v187 offset:16384
    s_waitcnt lgkmcnt(15)
    v_mfma_f32_16x16x32_bf16 v[214:217], v[60:63], v[4:7], v[214:217]
    ds_read_b64_tr_b16 v[162:163], v187 offset:16896
    v_mfma_f32_16x16x32_bf16 v[218:221], v[64:67], v[4:7], v[218:221]
    ds_read_b64_tr_b16 v[164:165], v188 offset:16384
    ds_read_b64_tr_b16 v[166:167], v188 offset:16896
    v_mfma_f32_16x16x32_bf16 v[222:225], v[68:71], v[4:7], v[222:225]
    ds_read_b64_tr_b16 v[168:169], v189 offset:6656
    s_waitcnt vmcnt(6)
    s_waitcnt lgkmcnt(15)
    v_mfma_f32_16x16x32_bf16 v[206:209], v[72:75], v[8:11], v[206:209]
    v_add_u32 v235, 8192, v235
    global_load_dwordx4 v[4:7], v235, s[48:49] offset:-4096 sc1
    v_mfma_f32_16x16x32_bf16 v[210:213], v[76:79], v[8:11], v[210:213]
    ds_read_b64_tr_b16 v[170:171], v189 offset:6720
    ds_read_b64_tr_b16 v[172:173], v185 offset:20480
    ds_read_b64_tr_b16 v[174:175], v185 offset:20992
    v_mfma_f32_16x16x32_bf16 v[214:217], v[80:83], v[8:11], v[214:217]
    ds_read_b64_tr_b16 v[176:177], v186 offset:20480
    ds_read_b64_tr_b16 v[178:179], v186 offset:20992
    s_waitcnt lgkmcnt(15)
    v_mfma_f32_16x16x32_bf16 v[218:221], v[84:87], v[8:11], v[218:221]
    ds_read_b64_tr_b16 v[36:37], v187 offset:20480
    v_mfma_f32_16x16x32_bf16 v[222:225], v[88:91], v[8:11], v[222:225]
    ds_read_b64_tr_b16 v[38:39], v187 offset:20992
    ds_read_b64_tr_b16 v[40:41], v188 offset:20480
    s_waitcnt vmcnt(6)
    v_mfma_f32_16x16x32_bf16 v[206:209], v[92:95], v[12:15], v[206:209]
    global_load_dwordx4 v[8:11], v235, s[48:49] offset:-3072 sc1
    s_waitcnt lgkmcnt(15)
    v_mfma_f32_16x16x32_bf16 v[210:213], v[96:99], v[12:15], v[210:213]
    ds_read_b64_tr_b16 v[42:43], v188 offset:20992
    ds_read_b64_tr_b16 v[44:45], v189 offset:7168
    ds_read_b64_tr_b16 v[46:47], v189 offset:7232
    v_mfma_f32_16x16x32_bf16 v[214:217], v[100:103], v[12:15], v[214:217]
    ds_read_b64_tr_b16 v[48:49], v185 offset:24576
    v_mfma_f32_16x16x32_bf16 v[218:221], v[104:107], v[12:15], v[218:221]
    ds_read_b64_tr_b16 v[50:51], v185 offset:25088
    ds_read_b64_tr_b16 v[52:53], v186 offset:24576
    s_waitcnt lgkmcnt(15)
    v_mfma_f32_16x16x32_bf16 v[222:225], v[108:111], v[12:15], v[222:225]
    ds_read_b64_tr_b16 v[54:55], v186 offset:25088
    s_waitcnt vmcnt(6)
    v_mfma_f32_16x16x32_bf16 v[206:209], v[112:115], v[16:19], v[206:209]
    ds_read_b64_tr_b16 v[56:57], v187 offset:24576
    ds_read_b64_tr_b16 v[58:59], v187 offset:25088
    v_mfma_f32_16x16x32_bf16 v[210:213], v[116:119], v[16:19], v[210:213]
    ds_read_b64_tr_b16 v[60:61], v188 offset:24576
    s_waitcnt lgkmcnt(15)
    v_mfma_f32_16x16x32_bf16 v[214:217], v[120:123], v[16:19], v[214:217]
    ds_read_b64_tr_b16 v[62:63], v188 offset:25088
    ds_read_b64_tr_b16 v[64:65], v189 offset:7680
    v_mfma_f32_16x16x32_bf16 v[218:221], v[124:127], v[16:19], v[218:221]
    ds_read_b64_tr_b16 v[66:67], v189 offset:7744
    v_mfma_f32_16x16x32_bf16 v[222:225], v[128:131], v[16:19], v[222:225]
    ds_read_b64_tr_b16 v[68:69], v185 offset:28672
    ds_read_b64_tr_b16 v[70:71], v185 offset:29184
    s_waitcnt vmcnt(5)
    s_waitcnt lgkmcnt(15)
    v_mfma_f32_16x16x32_bf16 v[206:209], v[132:135], v[20:23], v[206:209]
    ds_read_b64_tr_b16 v[72:73], v186 offset:28672
    v_mfma_f32_16x16x32_bf16 v[210:213], v[136:139], v[20:23], v[210:213]
    ds_read_b64_tr_b16 v[74:75], v186 offset:29184
    ds_read_b64_tr_b16 v[76:77], v187 offset:28672
    v_mfma_f32_16x16x32_bf16 v[214:217], v[140:143], v[20:23], v[214:217]
    ds_read_b64_tr_b16 v[78:79], v187 offset:29184
    s_waitcnt lgkmcnt(15)
    v_mfma_f32_16x16x32_bf16 v[218:221], v[144:147], v[20:23], v[218:221]
    ds_read_b64_tr_b16 v[80:81], v188 offset:28672
    ds_read_b64_tr_b16 v[82:83], v188 offset:29184
    v_mfma_f32_16x16x32_bf16 v[222:225], v[148:151], v[20:23], v[222:225]
    ds_read_b64_tr_b16 v[84:85], v189 offset:8192
    s_waitcnt vmcnt(4)
    v_mfma_f32_16x16x32_bf16 v[206:209], v[152:155], v[24:27], v[206:209]
    ds_read_b64_tr_b16 v[86:87], v189 offset:8256
    ds_read_b64_tr_b16 v[88:89], v185 offset:32768
    s_waitcnt lgkmcnt(15)
    v_mfma_f32_16x16x32_bf16 v[210:213], v[156:159], v[24:27], v[210:213]
    ds_read_b64_tr_b16 v[90:91], v185 offset:33280
    v_mfma_f32_16x16x32_bf16 v[214:217], v[160:163], v[24:27], v[214:217]
    ds_read_b64_tr_b16 v[92:93], v186 offset:32768
    ds_read_b64_tr_b16 v[94:95], v186 offset:33280
    v_mfma_f32_16x16x32_bf16 v[218:221], v[164:167], v[24:27], v[218:221]
    ds_read_b64_tr_b16 v[96:97], v187 offset:32768
    s_waitcnt lgkmcnt(15)
    v_mfma_f32_16x16x32_bf16 v[222:225], v[168:171], v[24:27], v[222:225]
    ds_read_b64_tr_b16 v[98:99], v187 offset:33280
    ds_read_b64_tr_b16 v[100:101], v188 offset:32768
    s_waitcnt vmcnt(3)
    v_mfma_f32_16x16x32_bf16 v[206:209], v[172:175], v[28:31], v[206:209]
    ds_read_b64_tr_b16 v[102:103], v188 offset:33280
    v_mfma_f32_16x16x32_bf16 v[210:213], v[176:179], v[28:31], v[210:213]
    ds_read_b64_tr_b16 v[104:105], v189 offset:8704
    ds_read_b64_tr_b16 v[106:107], v189 offset:8768
    s_waitcnt lgkmcnt(15)
    v_mfma_f32_16x16x32_bf16 v[214:217], v[36:39], v[28:31], v[214:217]
    v_mfma_f32_16x16x32_bf16 v[218:221], v[40:43], v[28:31], v[218:221]
    v_mfma_f32_16x16x32_bf16 v[222:225], v[44:47], v[28:31], v[222:225]
    s_waitcnt vmcnt(2)
    s_waitcnt lgkmcnt(15)
    v_mfma_f32_16x16x32_bf16 v[206:209], v[48:51], v[32:35], v[206:209]
    v_mfma_f32_16x16x32_bf16 v[210:213], v[52:55], v[32:35], v[210:213]
    v_mfma_f32_16x16x32_bf16 v[214:217], v[56:59], v[32:35], v[214:217]
    s_waitcnt lgkmcnt(15)
    v_mfma_f32_16x16x32_bf16 v[218:221], v[60:63], v[32:35], v[218:221]
    v_mfma_f32_16x16x32_bf16 v[222:225], v[64:67], v[32:35], v[222:225]
    s_waitcnt vmcnt(1)
    v_mfma_f32_16x16x32_bf16 v[206:209], v[68:71], v[4:7], v[206:209]
    s_waitcnt lgkmcnt(12)
    v_mfma_f32_16x16x32_bf16 v[210:213], v[72:75], v[4:7], v[210:213]
    v_mfma_f32_16x16x32_bf16 v[214:217], v[76:79], v[4:7], v[214:217]
    v_mfma_f32_16x16x32_bf16 v[218:221], v[80:83], v[4:7], v[218:221]
    s_waitcnt lgkmcnt(6)
    v_mfma_f32_16x16x32_bf16 v[222:225], v[84:87], v[4:7], v[222:225]
    s_waitcnt vmcnt(0)
    v_mfma_f32_16x16x32_bf16 v[206:209], v[88:91], v[8:11], v[206:209]
    v_mfma_f32_16x16x32_bf16 v[210:213], v[92:95], v[8:11], v[210:213]
    s_waitcnt lgkmcnt(0)
    v_mfma_f32_16x16x32_bf16 v[214:217], v[96:99], v[8:11], v[214:217]
    v_mfma_f32_16x16x32_bf16 v[218:221], v[100:103], v[8:11], v[218:221]
    v_mfma_f32_16x16x32_bf16 v[222:225], v[104:107], v[8:11], v[222:225]
    s_nop 2
    v_cvt_pk_bf16_f32 v206, v206, v207
    v_cvt_pk_bf16_f32 v207, v208, v209
    ds_write_b64 v234, v[206:207] offset:0
    v_cvt_pk_bf16_f32 v210, v210, v211
    v_cvt_pk_bf16_f32 v211, v212, v213
    ds_write_b64 v234, v[210:211] offset:32
    v_cvt_pk_bf16_f32 v214, v214, v215
    v_cvt_pk_bf16_f32 v215, v216, v217
    ds_write_b64 v234, v[214:215] offset:64
    v_cvt_pk_bf16_f32 v218, v218, v219
    v_cvt_pk_bf16_f32 v219, v220, v221
    ds_write_b64 v234, v[218:219] offset:96
    v_cvt_pk_bf16_f32 v222, v222, v223
    v_cvt_pk_bf16_f32 v223, v224, v225
    ds_write_b64 v234, v[222:223] offset:128
    ds_read_b128 v[40:43], v190
    ds_read_b128 v[44:47], v191
    ds_read_b128 v[48:51], v192
    s_waitcnt lgkmcnt(2)
    buffer_store_dwordx4 v[40:43], v193, s[8:11], s71 offen
    s_waitcnt lgkmcnt(1)
    buffer_store_dwordx4 v[44:47], v194, s[8:11], s71 offen
    s_waitcnt lgkmcnt(0)
    s_mov_b64 exec, 0xffff
    buffer_store_dwordx4 v[48:51], v195, s[8:11], s71 offen
    s_mov_b64 exec, -1
L_epoch:
    s_cmp_lg_u32 s2, 0
    s_cbranch_scc1 L_fin
    s_cmp_lg_u32 s3, 7
    s_cbranch_scc1 L_fin
    v_mov_b32 v5, s7
    s_mov_b64 exec, 1
    global_store_dword v254, v5, s[48:49] sc1
    s_mov_b64 exec, -1
L_fin:
L_exit:
    s_endpgm
Lspin_21_s:
    s_sleep 2
    s_branch Lspin_21
Lspin_22_s:
    s_sleep 4
    s_branch Lspin_22
Lspin_23_s:
    s_sleep 2
    s_branch Lspin_23
Lspin_24_s:
    s_sleep 4
    s_branch Lspin_24
Lspin_27_s:
    s_sleep 8
    s_branch Lspin_27
Lspin_28_s:
    s_sleep 2
    s_branch Lspin_28
Lspin_29_s:
    s_sleep 2
    s_branch Lspin_29
Lspin_30_s:
    s_sleep 8
    s_branch Lspin_30
Lspin_31_s:
    s_sleep 8
    s_branch Lspin_31
Lspin_32_s:
    s_sleep 1
    s_branch Lspin_32
L_pollo_s:
    s_sleep 1
    s_branch L_pollo
L_slow:
    s_waitcnt lgkmcnt(0)
    s_nop 15
    v_mov_b32 v164, 0
    v_mov_b32 v80, 0
    v_mov_b32 v165, 0
    v_mov_b32 v81, 0
    v_mov_b32 v166, 0
    v_mov_b32 v82, 0
    v_mov_b32 v167, 0
    v_mov_b32 v83, 0
    v_mov_b32 v168, 0
    v_mov_b32 v84, 0
    v_mov_b32 v169, 0
    v_mov_b32 v85, 0
    v_mov_b32 v170, 0
    v_mov_b32 v86, 0
    v_mov_b32 v171, 0
    v_mov_b32 v87, 0
    v_mov_b32 v172, 0
    v_mov_b32 v88, 0
    v_mov_b32 v173, 0
    v_mov_b32 v89, 0
    v_mov_b32 v174, 0
    v_mov_b32 v90, 0
    v_mov_b32 v175, 0
    v_mov_b32 v91, 0
    v_mov_b32 v176, 0
    v_mov_b32 v92, 0
    v_mov_b32 v177, 0
    v_mov_b32 v93, 0
    v_mov_b32 v178, 0
    v_mov_b32 v94, 0
    v_mov_b32 v179, 0
    v_mov_b32 v95, 0
    v_mov_b32 v180, 0
    v_mov_b32 v96, 0
    v_mov_b32 v181, 0
    v_mov_b32 v97, 0
    v_mov_b32 v182, 0
    v_mov_b32 v98, 0
    v_mov_b32 v183, 0
    v_mov_b32 v99, 0
    v_mov_b32 v184, 0
    v_mov_b32 v100, 0
    v_mov_b32 v185, 0
    v_mov_b32 v101, 0
    v_mov_b32 v186, 0
    v_mov_b32 v102, 0
    v_mov_b32 v187, 0
    v_mov_b32 v103, 0
    v_mov_b32 v188, 0
    v_mov_b32 v104, 0
    v_mov_b32 v189, 0
    v_mov_b32 v105, 0
    v_mov_b32 v190, 0
    v_mov_b32 v106, 0
    v_mov_b32 v191, 0
    v_mov_b32 v107, 0
    v_mov_b32 v192, 0
    v_mov_b32 v108, 0
    v_mov_b32 v193, 0
    v_mov_b32 v109, 0
    v_mov_b32 v194, 0
    v_mov_b32 v110, 0
    v_mov_b32 v195, 0
    v_mov_b32 v111, 0
    v_mov_b32 v196, 0xff800000
    v_mov_b32 v197, 0xff800000
    v_and_b32 v2, 31, v1
    v_lshlrev_b32 v2, 4, v2
    v_mov_b32 v149, 0
    s_mov_b32 s55, 0
L_sp:
    s_mov_b32 s56, 131072
L_sc:
    s_mov_b32 s57, 0
L_st:
    s_mul_i32 s58, s57, 2240
    s_add_u32 s58, s58, s56
    v_add_u32 v3, s58, v219
    v_add_u32 v4, s58, v220
    s_and_b32 s58, s57, 1
    s_lshl_b32 s58, s58, 9
    s_lshr_b32 s54, s57, 1
    s_lshl_b32 s54, s54, 2
    s_add_u32 s58, s58, s54
    s_add_u32 s58, s58, s56
    s_add_u32 s58, s58, 17920
    v_add_u32 v5, s58, v2
    global_load_dwordx4 v[124:127], v3, s[48:49] sc1
    global_load_dword v148, v5, s[48:49] sc1
    global_load_dwordx4 v[132:135], v4, s[48:49] sc1
    global_load_dwordx4 v[140:143], v4, s[48:49] offset:608 sc1
    s_waitcnt vmcnt(0)
    v_mfma_f32_32x32x4_2b_bf16 v[16:47], v[148:149], v[120:121], v[164:195]
    s_nop 15
    s_nop 1
    v_mfma_f32_32x32x16_bf16 v[16:31], v[124:127], v[112:115], v[16:31]
    v_mfma_f32_32x32x16_bf16 v[32:47], v[124:127], v[116:119], v[32:47]
    s_nop 15
    s_cmp_eq_u32 s55, 0
    s_cbranch_scc0 L_s2
    v_max3_f32 v196, v16, v17, v196
    v_max3_f32 v196, v18, v19, v196
    v_max3_f32 v196, v20, v21, v196
    v_max3_f32 v196, v22, v23, v196
    v_max3_f32 v196, v24, v25, v196
    v_max3_f32 v196, v26, v27, v196
    v_max3_f32 v196, v28, v29, v196
    v_max3_f32 v196, v30, v31, v196
    v_max3_f32 v197, v32, v33, v197
    v_max3_f32 v197, v34, v35, v197
    v_max3_f32 v197, v36, v37, v197
    v_max3_f32 v197, v38, v39, v197
    v_max3_f32 v197, v40, v41, v197
    v_max3_f32 v197, v42, v43, v197
    v_max3_f32 v197, v44, v45, v197
    v_max3_f32 v197, v46, v47, v197
    s_branch L_s3
L_s2:
    v_exp_f32 v16, v16
    v_exp_f32 v17, v17
    v_exp_f32 v18, v18
    v_exp_f32 v19, v19
    v_exp_f32 v20, v20
    v_exp_f32 v21, v21
    v_exp_f32 v22, v22
    v_exp_f32 v23, v23
    v_exp_f32 v24, v24
    v_exp_f32 v25, v25
    v_exp_f32 v26, v26
    v_exp_f32 v27, v27
    v_exp_f32 v28, v28
    v_exp_f32 v29, v29
    v_exp_f32 v30, v30
    v_exp_f32 v31, v31
    v_exp_f32 v32, v32
    v_exp_f32 v33, v33
    v_exp_f32 v34, v34
    v_exp_f32 v35, v35
    v_exp_f32 v36, v36
    v_exp_f32 v37, v37
    v_exp_f32 v38, v38
    v_exp_f32 v39, v39
    v_exp_f32 v40, v40
    v_exp_f32 v41, v41
    v_exp_f32 v42, v42
    v_exp_f32 v43, v43
    v_exp_f32 v44, v44
    v_exp_f32 v45, v45
    v_exp_f32 v46, v46
    v_exp_f32 v47, v47
    v_smfmac_f32_32x32x32_bf16 v[80:95], v[132:135], v[16:23], v233
    v_smfmac_f32_32x32x32_bf16 v[80:95], v[140:143], v[24:31], v233
    v_smfmac_f32_32x32x32_bf16 v[96:111], v[132:135], v[32:39], v233
    v_smfmac_f32_32x32x32_bf16 v[96:111], v[140:143], v[40:47], v233
L_s3:
    s_add_u32 s57, s57, 1
    s_cmp_lt_u32 s57, 8
    s_cbranch_scc1 L_st
    s_add_u32 s56, s56, 18944
    s_cmp_lt_u32 s56, 282624
    s_cbranch_scc1 L_sc
    s_nop 15
    s_cmp_lg_u32 s55, 0
    s_cbranch_scc1 L_norm
    v_mov_b32 v6, v196
    s_nop 1
    v_permlane32_swap_b32 v6, v196
    v_max_f32 v6, v6, v196
    v_sub_f32 v164, 0, v6
    v_sub_f32 v165, 0, v6
    v_sub_f32 v166, 0, v6
    v_sub_f32 v167, 0, v6
    v_sub_f32 v168, 0, v6
    v_sub_f32 v169, 0, v6
    v_sub_f32 v170, 0, v6
    v_sub_f32 v171, 0, v6
    v_sub_f32 v172, 0, v6
    v_sub_f32 v173, 0, v6
    v_sub_f32 v174, 0, v6
    v_sub_f32 v175, 0, v6
    v_sub_f32 v176, 0, v6
    v_sub_f32 v177, 0, v6
    v_sub_f32 v178, 0, v6
    v_sub_f32 v179, 0, v6
    v_mov_b32 v6, v197
    s_nop 1
    v_permlane32_swap_b32 v6, v197
    v_max_f32 v6, v6, v197
    v_sub_f32 v180, 0, v6
    v_sub_f32 v181, 0, v6
    v_sub_f32 v182, 0, v6
    v_sub_f32 v183, 0, v6
    v_sub_f32 v184, 0, v6
    v_sub_f32 v185, 0, v6
    v_sub_f32 v186, 0, v6
    v_sub_f32 v187, 0, v6
    v_sub_f32 v188, 0, v6
    v_sub_f32 v189, 0, v6
    v_sub_f32 v190, 0, v6
    v_sub_f32 v191, 0, v6
    v_sub_f32 v192, 0, v6
    v_sub_f32 v193, 0, v6
    v_sub_f32 v194, 0, v6
    v_sub_f32 v195, 0, v6
    s_mov_b32 s55, 1
    s_branch L_sp
.section .rodata,"a"
.p2align 6
.amdhsa_kernel concat_heads__grouped_kv_mqa__ssm_conv_s4__prompt_kernel
  .amdhsa_next_free_vgpr 256
  .amdhsa_next_free_sgpr 102
  .amdhsa_accum_offset 256
  .amdhsa_group_segment_fixed_size 0
  .amdhsa_kernarg_size 136
  .amdhsa_user_sgpr_count 2
  .amdhsa_user_sgpr_kernarg_segment_ptr 1
  .amdhsa_system_sgpr_workgroup_id_x 1
.end_amdhsa_kernel
```
